```python
import torch

def _softmax(x, axis=-1):
    return torch.softmax(x, dim=axis)
def _gelu(x):
    return torch.nn.functional.gelu(x, approximate="tanh")
def _silu(x):
    return torch.nn.functional.silu(x)
def _sigmoid(x):
    return torch.sigmoid(x)
def _layernorm(x, axis=-1, eps=1e-5):
    m = x.mean(dim=axis, keepdim=True)
    v = x.var(dim=axis, keepdim=True, unbiased=False)
    return (x - m) / torch.sqrt(v + eps)
def _scatter_add(tgt, idx, src, axis=0):
    return tgt.clone().index_add_(axis, idx, src)
def _segment_sum(src, seg, n):
    out = torch.zeros((n,) + src.shape[1:], dtype=src.dtype)
    return out.index_add_(0, seg, src)
def _pad(x, pw):
    flat = tuple(v for pair in reversed(pw) for v in pair)
    return torch.nn.functional.pad(x, flat)

kernel_name = 'recurrent_scan__sliding_block_cached__geglu_ffn__decode'

def setup_inputs():

    _w = (lambda a: (lambda t: t.to(torch.bfloat16) if t.is_floating_point() else t)(torch.as_tensor(a)))
    def _A_setup():
        B, Sq, D = 1, 1, 1024
        Hq, Hkv, Sk, Dh = 32, 4, 65536, 128
        assert Hq % Hkv == 0, (Hq, Hkv)
        return {
            "x": _w((lambda *s: torch.randn(*s, dtype=torch.bfloat16) * 0.05)(B, Sq, D)),
            "k_cache": _w((lambda *s: torch.randn(*s, dtype=torch.bfloat16) * 1.6)(B, Hkv, Sk, Dh)),
            "v_cache": _w((lambda *s: torch.randn(*s, dtype=torch.bfloat16) * 0.2)(B, Hkv, Sk, Dh)),
            "wq": _w((lambda *s: torch.randn(*s, dtype=torch.bfloat16) * 1.6)(D, Hq * Dh) * (D ** -0.5)),
            "wo": _w((lambda *s: torch.randn(*s, dtype=torch.bfloat16) * 0.2)(Hq * Dh, D) * ((Hq * Dh) ** -0.5)),
        }
    _A_in = _A_setup()

    def _B_setup():
        B, S, D, F = 1, 1, 1024, 3584
        return {
            "x": _w((lambda *s: torch.randn(*s, dtype=torch.bfloat16) * 0.05)(B, S, D)),
            "w_gate": _w((lambda *s: torch.randn(*s, dtype=torch.bfloat16) * 0.1)(D, F)),
            "w_up": _w((lambda *s: torch.randn(*s, dtype=torch.bfloat16) * 0.1)(D, F)),
            "w_down": _w((lambda *s: torch.randn(*s, dtype=torch.bfloat16) * 0.1)(F, D)),
        }
    _B_in = _B_setup()

    return {
        "A_x": _A_in["x"],
        "A_k_cache": _A_in["k_cache"],
        "A_v_cache": _A_in["v_cache"],
        "A_wq": _A_in["wq"],
        "A_wo": _A_in["wo"],
        "B_x": _B_in["x"],
        "B_w_gate": _B_in["w_gate"],
        "B_w_up": _B_in["w_up"],
        "B_w_down": _B_in["w_down"],
    }

def reference(A_x, A_k_cache, A_v_cache, A_wq, A_wo, B_x, B_w_gate, B_w_up, B_w_down):
    def _A_ref(x, k_cache, v_cache, wq, wo):
        B, Sq, D = x.shape
        Hq, Dh = 32, 128
        Hkv, Sk = k_cache.shape[1], k_cache.shape[2]
        W = min(4096, max(256, Sk // 4))
        rep = Hq // Hkv
        q = (lambda x, *d: x.permute(*d))((x @ wq).reshape(B, Sq, Hq, Dh), 0, 2, 1, 3)
        k = (lambda x, n, axis: torch.repeat_interleave(x, n, dim=axis))(k_cache[:, :, Sk - W:, :], rep, axis=1)
        v = (lambda x, n, axis: torch.repeat_interleave(x, n, dim=axis))(v_cache[:, :, Sk - W:, :], rep, axis=1)
        scores = torch.einsum("bhqd,bhkd->bhqk", q, k) * (Dh ** -0.5)
        p = _softmax(scores, axis=-1)
        o = torch.einsum("bhqk,bhkd->bhqd", p, v)
        return (lambda x, *d: x.permute(*d))(o, 0, 2, 1, 3).reshape(B, Sq, Hq * Dh) @ wo

    def _B_ref(x, w_gate, w_up, w_down):
        return (_gelu(x @ w_gate) * (x @ w_up)) @ w_down

    x = A_x
    xn = _layernorm(x, axis=-1)
    s = _A_ref(xn, A_k_cache, A_v_cache, A_wq, A_wo)
    g = _silu(_B_ref(xn, B_w_gate, B_w_up, B_w_down))
    return x + s * g
```

```asm
; @launch grid=(256,1,1) block=(512,1,1) lds=77824
.amdgcn_target "amdgcn-amd-amdhsa--gfx950"
.text
.globl recurrent_scan__sliding_block_cached__geglu_ffn__decode_kernel
.p2align 12
.p2align 8
.type recurrent_scan__sliding_block_cached__geglu_ffn__decode_kernel,@function
recurrent_scan__sliding_block_cached__geglu_ffn__decode_kernel:
    s_cmp_ge_u32 s2, 256
    s_cbranch_scc1 L_end
    s_load_dwordx16 s[4:19], s[0:1], 0
    s_load_dwordx8 s[20:27], s[0:1], 64
    v_lshrrev_b32 v1, 6, v0
    s_and_b32 s28, s2, 7
    s_lshr_b32 s29, s2, 3
    v_readfirstlane_b32 s3, v1
    s_getpc_b64 s[46:47]
L_pc:
    s_lshl_b32 s42, s29, 9
    v_add_u32 v1, s42, v0
    v_min_u32 v1, L_codeend-L_pc-4, v1
    s_mov_b64 exec, 1
    global_load_ubyte v55, v1, s[46:47]
    s_mov_b64 exec, -1
    v_and_b32 v0, 63, v0
    s_lshr_b32 s34, s28, 1
    s_and_b32 s97, s28, 1
    s_xor_b32 s97, s97, 1
    s_mov_b32 s35, s29
    s_and_b32 s30, s29, 3
    s_lshr_b32 s40, s29, 2
    s_lshl3_add_u32 s31, s34, s40
    s_lshl2_add_u32 s32, s97, s30
    s_mul_i32 s41, s34, s97
    s_sub_u32 s33, s31, s41
    s_add_u32 s98, s40, 2
    s_cmp_ge_u32 s98, 7
    s_cselect_b32 s41, 7, 0
    s_sub_u32 s98, s98, s41
    s_sub_u32 s98, s98, s40
    s_add_u32 s98, s98, s33
    s_lshl2_add_u32 s99, s34, s30
    s_cmp_eq_u32 s40, 7
    s_cselect_b32 s41, s97, 0
    s_add_u32 s97, s97, s41
    s_cmp_eq_u32 s97, 1
    s_cselect_b32 s33, s29, s33
    s_cselect_b32 s30, s34, s30
    s_xor_b32 s98, s33, 2
    s_movk_i32 s44, 0x3ff
    v_and_b32 v4, 15, v0
    v_lshrrev_b32 v5, 4, v0
    s_cmp_lt_u32 s3, 4
    s_cbranch_scc1 L_awave
L_swave:
    s_sub_u32 s3, s3, 4
    s_lshl2_add_u32 s40, s32, s3
    s_lshl_b32 s40, s40, 18
    s_lshl_b32 s41, s31, 8
    s_add_u32 s40, s40, s41
    v_lshlrev_b32 v13, 4, v4
    v_lshl_add_u32 v6, v5, 13, v13
    v_add_u32 v6, s40, v6
    s_mov_b32 s45, 0x8000
    s_waitcnt lgkmcnt(0)
    global_load_dwordx4 v[56:59], v6, s[10:11] nt
    v_add_u32 v6, s45, v6
    global_load_dwordx4 v[60:63], v6, s[10:11] nt
    v_add_u32 v6, s45, v6
    global_load_dwordx4 v[64:67], v6, s[10:11] nt
    v_add_u32 v6, s45, v6
    global_load_dwordx4 v[68:71], v6, s[10:11] nt
    v_add_u32 v6, s45, v6
    global_load_dwordx4 v[72:75], v6, s[10:11] nt
    v_add_u32 v6, s45, v6
    global_load_dwordx4 v[76:79], v6, s[10:11] nt
    v_add_u32 v6, s45, v6
    global_load_dwordx4 v[80:83], v6, s[10:11] nt
    v_add_u32 v6, s45, v6
    global_load_dwordx4 v[84:87], v6, s[10:11] nt
    s_load_dword s36, s[26:27], 0
    v_lshrrev_b32 v12, 3, v0
    v_and_b32 v1, 7, v0
    v_lshlrev_b32 v2, 4, v1
    v_lshl_add_u32 v10, v12, 11, v2
    s_lshl2_add_u32 s42, s30, s3
    s_lshl_b32 s40, s42, 7
    s_lshl_b32 s41, s33, 18
    s_add_u32 s40, s40, s41
    v_add_u32 v10, s40, v10
    s_movk_i32 s45, 0x4000
    v_lshl_add_u32 v1, v1, 1, v5
    s_lshl_b32 s40, s42, 8
    v_lshl_add_u32 v14, v1, 4, s40
    v_lshl_add_u32 v11, v4, 1, v5
    v_lshlrev_b32 v11, 4, v11
    s_mov_b32 s40, 0xaaaaaaaa
    s_mov_b32 s41, 0xaaaaaaaa
    v_mov_b32 v1, 0x0c0c0100
    v_mov_b32 v2, 0x01000c0c
    v_cndmask_b32 v1, v1, v2, s[40:41]
    v_mov_b32 v2, 0x0c0c0302
    v_mov_b32 v3, 0x03020c0c
    v_cndmask_b32 v2, v2, v3, s[40:41]
    v_mov_b32 v3, 0x0c0c0c0c
    s_mov_b32 s40, 0x3030303
    s_mov_b32 s41, 0x3030303
    v_cndmask_b32 v16, v3, v1, s[40:41]
    v_cndmask_b32 v20, v3, v2, s[40:41]
    s_mov_b32 s40, 0xc0c0c0c
    s_mov_b32 s41, 0xc0c0c0c
    v_cndmask_b32 v17, v3, v1, s[40:41]
    v_cndmask_b32 v21, v3, v2, s[40:41]
    s_mov_b32 s40, 0x30303030
    s_mov_b32 s41, 0x30303030
    v_cndmask_b32 v18, v3, v1, s[40:41]
    v_cndmask_b32 v22, v3, v2, s[40:41]
    s_mov_b32 s40, 0xc0c0c0c0
    s_mov_b32 s41, 0xc0c0c0c0
    v_cndmask_b32 v19, v3, v1, s[40:41]
    v_cndmask_b32 v23, v3, v2, s[40:41]
    s_barrier
    s_waitcnt lgkmcnt(0)
    s_add_u32 s36, s36, 1
    s_and_b32 s37, s36, s44
    v_mov_b32 v3, s37
    s_cmp_ge_u32 s97, 1
    s_cbranch_scc1 L_s_notattn
    s_branch L_sdispatch
L_awave:
    s_setprio 3
    s_lshl2_add_u32 s40, s30, s3
    s_lshl_b32 s40, s40, 6
    v_lshlrev_b32 v14, 5, v0
    v_add_lshl_u32 v1, v0, s40, 1
    s_lshl2_add_u32 s40, s32, s3
    s_lshl_b32 s40, s40, 5
    v_and_b32 v15, 31, v0
    v_add_lshl_u32 v15, v15, s40, 1
    v_mov_b32 v10, 0
    v_and_b32 v2, 31, v0
    v_lshlrev_b32 v2, 2, v2
    ds_write_b32 v2, v10 offset:12032
    s_waitcnt lgkmcnt(0)
    global_load_dwordx4 v[72:75], v14, s[4:5]
    global_load_dwordx4 v[76:79], v14, s[4:5] offset:16
    global_load_ushort v80, v15, s[4:5]
    global_load_ushort v81, v1, s[4:5]
    s_load_dword s36, s[26:27], 0
    s_barrier
    s_waitcnt lgkmcnt(0)
    s_cmp_lg_u32 s3, 0
    s_cbranch_scc1 Lnoxt_24
    s_getreg_b32 s45, hwreg(HW_REG_XCC_ID, 0, 4)
    s_lshl_b32 s45, s45, 28
    s_add_u32 s41, s36, 1
    s_xor_b32 s45, s45, s41
    s_lshl_b32 s95, s28, 7
    s_add_u32 s95, s95, 0x3400
    s_lshl2_add_u32 s41, s29, s95
    s_mov_b64 exec, 1
    v_mov_b32 v1, s41
    v_mov_b32 v2, s45
    global_store_dword v1, v2, s[26:27] sc1
    s_mov_b64 exec, -1
    s_waitcnt vmcnt(1)
    s_branch Lnoxt_24_ln
Lnoxt_24:
    s_waitcnt vmcnt(0)
Lnoxt_24_ln:
    v_lshlrev_b32 v56, 16, v72
    v_and_b32 v57, 0xffff0000, v72
    v_lshlrev_b32 v58, 16, v73
    v_and_b32 v59, 0xffff0000, v73
    v_lshlrev_b32 v60, 16, v74
    v_and_b32 v61, 0xffff0000, v74
    v_lshlrev_b32 v62, 16, v75
    v_and_b32 v63, 0xffff0000, v75
    v_lshlrev_b32 v64, 16, v76
    v_and_b32 v65, 0xffff0000, v76
    v_lshlrev_b32 v66, 16, v77
    v_and_b32 v67, 0xffff0000, v77
    v_lshlrev_b32 v68, 16, v78
    v_and_b32 v69, 0xffff0000, v78
    v_lshlrev_b32 v70, 16, v79
    v_and_b32 v71, 0xffff0000, v79
    v_pk_add_f32 v[16:17], v[56:57], v[58:59]
    v_pk_add_f32 v[18:19], v[60:61], v[62:63]
    v_pk_add_f32 v[16:17], v[16:17], v[64:65]
    v_pk_add_f32 v[18:19], v[18:19], v[66:67]
    v_pk_add_f32 v[16:17], v[16:17], v[68:69]
    v_pk_add_f32 v[18:19], v[18:19], v[70:71]
    v_pk_add_f32 v[16:17], v[16:17], v[18:19]
    v_add_f32 v16, v16, v17
    s_nop 1
    v_add_f32_dpp v16, v16, v16 quad_perm:[1,0,3,2] row_mask:0xf bank_mask:0xf
    s_nop 1
    v_add_f32_dpp v16, v16, v16 quad_perm:[2,3,0,1] row_mask:0xf bank_mask:0xf
    s_nop 1
    v_add_f32_dpp v16, v16, v16 row_half_mirror row_mask:0xf bank_mask:0xf
    s_nop 1
    v_add_f32_dpp v16, v16, v16 row_mirror row_mask:0xf bank_mask:0xf
    v_mov_b32 v17, v16
    s_nop 1
    v_permlane32_swap_b32 v17, v16
    v_add_f32 v16, v16, v17
    v_mov_b32 v17, v16
    s_nop 1
    v_permlane16_swap_b32 v17, v16
    v_add_f32 v16, v16, v17
    v_mul_f32 v16, 0x3a800000, v16
    v_pk_add_f32 v[56:57], v[56:57], v[16:17] op_sel_hi:[1,0] neg_lo:[0,1] neg_hi:[0,1]
    v_pk_add_f32 v[58:59], v[58:59], v[16:17] op_sel_hi:[1,0] neg_lo:[0,1] neg_hi:[0,1]
    v_pk_add_f32 v[60:61], v[60:61], v[16:17] op_sel_hi:[1,0] neg_lo:[0,1] neg_hi:[0,1]
    v_pk_add_f32 v[62:63], v[62:63], v[16:17] op_sel_hi:[1,0] neg_lo:[0,1] neg_hi:[0,1]
    v_pk_add_f32 v[64:65], v[64:65], v[16:17] op_sel_hi:[1,0] neg_lo:[0,1] neg_hi:[0,1]
    v_pk_add_f32 v[66:67], v[66:67], v[16:17] op_sel_hi:[1,0] neg_lo:[0,1] neg_hi:[0,1]
    v_pk_add_f32 v[68:69], v[68:69], v[16:17] op_sel_hi:[1,0] neg_lo:[0,1] neg_hi:[0,1]
    v_pk_add_f32 v[70:71], v[70:71], v[16:17] op_sel_hi:[1,0] neg_lo:[0,1] neg_hi:[0,1]
    v_pk_mul_f32 v[18:19], v[56:57], v[56:57]
    v_pk_mul_f32 v[20:21], v[58:59], v[58:59]
    v_pk_fma_f32 v[18:19], v[60:61], v[60:61], v[18:19]
    v_pk_fma_f32 v[20:21], v[62:63], v[62:63], v[20:21]
    v_pk_fma_f32 v[18:19], v[64:65], v[64:65], v[18:19]
    v_pk_fma_f32 v[20:21], v[66:67], v[66:67], v[20:21]
    v_pk_fma_f32 v[18:19], v[68:69], v[68:69], v[18:19]
    v_pk_fma_f32 v[20:21], v[70:71], v[70:71], v[20:21]
    v_pk_add_f32 v[18:19], v[18:19], v[20:21]
    v_add_f32 v18, v18, v19
    v_cvt_pk_bf16_f32 v16, v16, v16
    v_and_b32 v16, 0xffff0000, v16
    s_nop 1
    v_add_f32_dpp v18, v18, v18 quad_perm:[1,0,3,2] row_mask:0xf bank_mask:0xf
    s_nop 1
    v_add_f32_dpp v18, v18, v18 quad_perm:[2,3,0,1] row_mask:0xf bank_mask:0xf
    s_nop 1
    v_add_f32_dpp v18, v18, v18 row_half_mirror row_mask:0xf bank_mask:0xf
    s_nop 1
    v_add_f32_dpp v18, v18, v18 row_mirror row_mask:0xf bank_mask:0xf
    v_lshlrev_b32 v80, 16, v80
    v_lshlrev_b32 v81, 16, v81
    v_pk_add_f32 v[80:81], v[80:81], v[16:17] op_sel_hi:[1,0] neg_lo:[0,1] neg_hi:[0,1]
    v_mov_b32 v19, v18
    s_nop 1
    v_permlane32_swap_b32 v19, v18
    v_add_f32 v18, v18, v19
    v_mov_b32 v19, v18
    s_nop 1
    v_permlane16_swap_b32 v19, v18
    v_add_f32 v18, v18, v19
    v_mul_f32 v18, 0x3a800000, v18
    v_cvt_pk_bf16_f32 v18, v18, v18
    v_and_b32 v18, 0xffff0000, v18
    v_add_f32 v18, 0x3727c5ac, v18
    v_cvt_pk_bf16_f32 v18, v18, v18
    v_and_b32 v18, 0xffff0000, v18
    v_sqrt_f32 v18, v18
    v_cvt_pk_bf16_f32 v81, v80, v81
    v_lshlrev_b32 v80, 16, v81
    v_and_b32 v81, 0xffff0000, v81
    v_cvt_pk_bf16_f32 v18, v18, v18
    v_and_b32 v18, 0xffff0000, v18
    v_rcp_f32 v18, v18
    v_and_b32 v1, 3, v0
    v_lshrrev_b32 v2, 2, v0
    v_lshlrev_b32 v2, 1, v2
    v_pk_mul_f32 v[80:81], v[80:81], v[18:19] op_sel_hi:[1,0]
    s_lshl_b32 s40, s3, 6
    v_lshl_add_u32 v10, v1, 4, s40
    v_lshl_add_u32 v11, v10, 1, v2
    v_add_u32 v10, v10, v2
    v_cvt_pk_bf16_f32 v80, v80, v81
    s_lshl_b32 s40, s3, 2
    v_mov_b32 v2, s40
    v_mov_b32 v1, 1
    ds_write_b16_d16_hi v11, v80 offset:9472
    s_mov_b32 exec_hi, 0
    ds_write_b16 v10, v80 offset:9216
    s_mov_b64 exec, 1
    ds_write_b32 v2, v1 offset:12080
    s_mov_b64 exec, -1
    s_add_u32 s36, s36, 1
    s_and_b32 s37, s36, s44
    v_mov_b32 v3, s37
    s_cmp_eq_u32 s3, 3
    s_cbranch_scc0 Lnoq_25
    v_lshlrev_b32 v10, 4, v0
    s_lshl3_add_u32 s41, s31, s32
    s_lshl_b32 s40, s41, 9
    s_add_u32 s40, s40, 0x10000
    v_add_u32 v11, s40, v10
    s_lshr_b32 s40, s41, 4
    s_and_b32 s41, s41, 15
    s_lshl_b32 s40, s40, 5
    s_add_u32 s40, s40, s41
    s_lshl_b32 s40, s40, 2
    s_add_u32 s40, s40, 0x130000
    v_mov_b32 v1, 12032
    s_mov_b32 s38, 0
Lspin_26:
    ds_read_b32 v2, v1
    ds_read_b128 v[16:19], v10 offset:0
    ds_read_b128 v[20:23], v10 offset:512
    ds_read_b128 v[24:27], v10 offset:1024
    ds_read_b128 v[28:31], v10 offset:1536
    s_add_u32 s38, s38, 1
    s_cmp_gt_u32 s38, 1048576
    s_cbranch_scc1 L_end
    s_waitcnt lgkmcnt(0)
    v_readfirstlane_b32 s39, v2
    s_cmp_eq_u32 s39, 4
    s_cbranch_scc1 Lgot_27
    s_sleep 1
    s_branch Lspin_26
Lgot_27:
    s_mov_b32 exec_hi, 0
    v_pk_add_f32 v[16:17], v[16:17], v[20:21]
    v_pk_add_f32 v[24:25], v[24:25], v[28:29]
    v_pk_add_f32 v[18:19], v[18:19], v[22:23]
    v_pk_add_f32 v[26:27], v[26:27], v[30:31]
    v_pk_add_f32 v[16:17], v[16:17], v[24:25]
    v_pk_add_f32 v[18:19], v[18:19], v[26:27]
    v_add_u32 v16, 0x200, v16
    v_add_u32 v17, 0x200, v17
    v_add_u32 v18, 0x200, v18
    v_add_u32 v19, 0x200, v19
    v_bfi_b32 v16, s44, v3, v16
    v_bfi_b32 v17, s44, v3, v17
    v_bfi_b32 v18, s44, v3, v18
    v_bfi_b32 v19, s44, v3, v19
    global_store_dwordx4 v11, v[16:19], s[26:27] sc1
    s_mov_b64 exec, 15
    v_mul_u32_u24 v1, 2176, v0
    v_add_u32 v1, s40, v1
    v_mov_b32 v2, s36
    global_store_dword v1, v2, s[26:27] sc1
    s_mov_b64 exec, -1
Lnoq_25:
    s_cmp_lg_u32 s3, 0
    s_cbranch_scc1 Lnocol_28
    s_lshl_b32 s46, s28, 10
    s_add_u32 s46, s46, 0x8000
    s_mov_b32 s38, 0
    s_cmp_lg_u32 s29, 0
    s_cbranch_scc1 Lxm_30
    s_mov_b32 s42, s45
    s_mov_b32 s43, s45
    s_mov_b32 s101, 0
    s_add_u32 s41, s95, 128
Lxt_29:
    s_load_dwordx16 s[48:63], s[26:27], s95 glc
    s_add_u32 s38, s38, 1
    s_cmp_gt_u32 s38, 1048576
    s_cbranch_scc1 L_end
    s_waitcnt lgkmcnt(0)
    s_xor_b64 s[48:49], s[48:49], s[42:43]
    s_xor_b64 s[50:51], s[50:51], s[42:43]
    s_xor_b64 s[52:53], s[52:53], s[42:43]
    s_xor_b64 s[54:55], s[54:55], s[42:43]
    s_xor_b64 s[56:57], s[56:57], s[42:43]
    s_xor_b64 s[58:59], s[58:59], s[42:43]
    s_xor_b64 s[60:61], s[60:61], s[42:43]
    s_xor_b64 s[62:63], s[62:63], s[42:43]
    s_or_b64 s[48:49], s[48:49], s[50:51]
    s_or_b64 s[48:49], s[48:49], s[52:53]
    s_or_b64 s[48:49], s[48:49], s[54:55]
    s_or_b64 s[48:49], s[48:49], s[56:57]
    s_or_b64 s[48:49], s[48:49], s[58:59]
    s_or_b64 s[48:49], s[48:49], s[60:61]
    s_or_b64 s[48:49], s[48:49], s[62:63]
    s_or_b32 s48, s48, s49
    s_and_b32 s49, s48, 0x0fffffff
    s_cbranch_scc1 Lxt_29
    s_or_b32 s101, s101, s48
    s_add_u32 s95, s95, 64
    s_cmp_lt_u32 s95, s41
    s_cbranch_scc1 Lxt_29
    s_xor_b32 s40, s101, s36
    s_mov_b64 exec, 0xff
    v_lshl_add_u32 v1, v0, 7, s46
    v_mov_b32 v2, s40
    global_store_dword v1, v2, s[26:27] sc1
    s_branch Lxv_31
Lxm_30:
    s_and_b32 s40, s29, 7
    s_lshl_b32 s40, s40, 7
    s_add_u32 s46, s46, s40
Lxm_30_l:
    s_sleep 10
    s_load_dword s101, s[26:27], s46 glc
    s_add_u32 s38, s38, 1
    s_cmp_gt_u32 s38, 1048576
    s_cbranch_scc1 L_end
    s_waitcnt lgkmcnt(0)
    s_xor_b32 s101, s101, s36
    s_and_b32 s40, s101, 0x0fffffff
    s_cbranch_scc1 Lxm_30_l
Lxv_31:
    s_cmp_lg_u32 s101, 0
    s_cselect_b32 s40, 3, 1
    s_mov_b64 exec, 1
    v_mov_b32 v1, 12068
    v_mov_b32 v2, s40
    ds_write_b32 v1, v2
    s_mov_b64 exec, -1
Lnocol_28:
    s_cmp_ge_u32 s97, 2
    s_cbranch_scc1 L_final
    s_cmp_ge_u32 s97, 1
    s_cbranch_scc1 L_ffn
    s_lshl2_add_u32 s41, s34, s3
    s_lshl_b32 s40, s41, 13
    s_add_u32 s40, s40, 0x10800
    v_and_b32 v12, 31, v0
    v_lshrrev_b32 v13, 5, v0
    v_lshlrev_b32 v1, 4, v12
    v_lshl_add_u32 v1, v13, 12, v1
    v_add_u32 v6, s40, v1
    s_and_b32 s40, s35, 3
    s_mul_i32 s40, s40, 2176
    s_lshl_b32 s41, s41, 7
    s_add_u32 s40, s40, s41
    s_add_u32 s95, s40, 0x130000
    s_lshl_b32 s40, s3, 1
    v_add_u32 v13, s40, v13
    v_mul_u32_u24 v13, 272, v13
    v_lshl_add_u32 v13, v12, 3, v13
    v_and_b32 v10, 7, v0
    s_lshl_b32 s40, s34, 5
    s_add_u32 s41, s40, s35
    s_mul_i32 s41, s41, 4224
    s_lshl_b32 s42, s3, 7
    s_add_u32 s41, s41, s42
    s_add_u32 s41, s41, 0xa0000
    v_lshlrev_b32 v8, 9, v10
    v_bfe_u32 v11, v0, 3, 1
    v_lshl_add_u32 v8, v11, 6, v8
    v_lshl_add_u32 v8, v5, 4, v8
    v_add_u32 v8, s41, v8
    s_add_u32 s40, s40, s35
    s_lshl_b32 s40, s40, 7
    s_add_u32 s40, s40, 0x4000
    v_lshl_add_u32 v9, v10, 4, s40
    v_mul_u32_u24 v12, 272, v10
    v_lshl_add_u32 v12, v5, 4, v12
    s_mov_b32 s46, 0x3db504f3
    s_mov_b32 s47, 0x3db504f3
    s_lshl_b32 s40, s3, 13
    v_xor_b32 v14, v4, v5
    v_lshlrev_b32 v14, 4, v14
    v_lshl_add_u32 v14, v4, 8, v14
    v_add_u32 v14, s40, v14
    v_bfe_u32 v10, v0, 2, 2
    v_lshl_add_u32 v10, v5, 2, v10
    v_and_b32 v11, 7, v10
    v_lshlrev_b32 v11, 1, v11
    v_bfe_u32 v1, v0, 1, 1
    v_xor_b32 v11, v11, v1
    v_lshlrev_b32 v11, 4, v11
    v_lshl_add_u32 v11, v10, 8, v11
    v_and_b32 v1, 1, v0
    v_lshl_add_u32 v11, v1, 3, v11
    s_add_u32 s41, s40, 45056
    v_add_u32 v11, s41, v11
    v_lshl_add_u32 v15, v0, 4, s40
    s_lshl_b32 s41, s3, 10
    v_lshl_add_u32 v10, v0, 4, s41
    s_mov_b32 s92, 0xff00ff00
    s_mov_b32 s93, 0xff00ff00
    s_lshl_b32 s41, s3, 2
    s_add_u32 s41, s41, 12096
    v_mov_b32 v1, s41
    s_mov_b32 s38, 0
Lspin_32:
    ds_read_b32 v2, v1
    s_add_u32 s38, s38, 1
    s_cmp_gt_u32 s38, 1048576
    s_cbranch_scc1 L_end
    s_waitcnt lgkmcnt(0)
    v_readfirstlane_b32 s39, v2
    s_cmp_eq_u32 s39, 1
    s_cbranch_scc1 Lgot_33
    s_sleep 1
    s_branch Lspin_32
Lgot_33:
    ds_read_b128 v[56:59], v14 offset:12288
    ds_read_b128 v[72:75], v14 offset:16384
    v_xor_b32 v2, 64, v14
    ds_read_b128 v[60:63], v2 offset:12288
    ds_read_b128 v[76:79], v2 offset:16384
    v_xor_b32 v2, 128, v14
    ds_read_b128 v[64:67], v2 offset:12288
    ds_read_b128 v[80:83], v2 offset:16384
    v_xor_b32 v2, 192, v14
    ds_read_b128 v[68:71], v2 offset:12288
    ds_read_b128 v[84:87], v2 offset:16384
    s_mov_b32 s40, s95
    s_mov_b32 s38, 0
    s_mov_b32 s42, s36
    s_mov_b32 s43, s36
    s_branch Lpoll_34
Lretry_35:
    s_sleep 1
Lpoll_34:
    s_load_dwordx16 s[48:63], s[26:27], s40 glc
    s_add_u32 s38, s38, 1
    s_cmp_gt_u32 s38, 1048576
    s_cbranch_scc1 L_end
    s_waitcnt lgkmcnt(0)
    s_cmp_eq_u64 s[48:49], s[42:43]
    s_cbranch_scc0 Lretry_35
    s_cmp_eq_u64 s[50:51], s[42:43]
    s_cbranch_scc0 Lretry_35
    s_cmp_eq_u64 s[52:53], s[42:43]
    s_cbranch_scc0 Lretry_35
    s_cmp_eq_u64 s[54:55], s[42:43]
    s_cbranch_scc0 Lretry_35
    s_cmp_eq_u64 s[56:57], s[42:43]
    s_cbranch_scc0 Lretry_35
    s_cmp_eq_u64 s[58:59], s[42:43]
    s_cbranch_scc0 Lretry_35
    s_cmp_eq_u64 s[60:61], s[42:43]
    s_cbranch_scc0 Lretry_35
    s_cmp_eq_u64 s[62:63], s[42:43]
    s_cbranch_scc0 Lretry_35
Lflag_36:
    s_mov_b32 s45, 0
Lgq_37:
    global_load_dwordx4 v[120:123], v6, s[26:27] offset:-2048 sc1
    global_load_dwordx4 v[124:127], v6, s[26:27] offset:-1536 sc1
    global_load_dwordx4 v[128:131], v6, s[26:27] offset:-1024 sc1
    global_load_dwordx4 v[132:135], v6, s[26:27] offset:-512 sc1
    global_load_dwordx4 v[136:139], v6, s[26:27] offset:0 sc1
    global_load_dwordx4 v[140:143], v6, s[26:27] offset:512 sc1
    global_load_dwordx4 v[144:147], v6, s[26:27] offset:1024 sc1
    global_load_dwordx4 v[148:151], v6, s[26:27] offset:1536 sc1
    s_cmp_lg_u32 s45, 0
    s_cbranch_scc1 Lkvdone_38
    s_mov_b32 s45, 1
    s_mov_b64 exec, 1
    v_mov_b32 v1, 12056
    v_mov_b32 v2, 1
    ds_add_u32 v1, v2
    s_mov_b64 exec, -1
    s_lshl_b32 s41, s3, 2
    s_add_u32 s41, s41, 12112
    v_mov_b32 v1, s41
    s_mov_b32 s38, 0
Lspin_39:
    ds_read_b32 v2, v1
    s_add_u32 s38, s38, 1
    s_cmp_gt_u32 s38, 1048576
    s_cbranch_scc1 L_end
    s_waitcnt lgkmcnt(0)
    v_readfirstlane_b32 s39, v2
    s_cmp_eq_u32 s39, 1
    s_cbranch_scc0 Lspin_39
    ds_read_b64_tr_b16 v[88:89], v11 offset:0
    ds_read_b64_tr_b16 v[90:91], v11 offset:4096
    v_xor_b32 v14, 32, v11
    ds_read_b64_tr_b16 v[92:93], v14 offset:0
    ds_read_b64_tr_b16 v[94:95], v14 offset:4096
    v_xor_b32 v14, 64, v11
    ds_read_b64_tr_b16 v[96:97], v14 offset:0
    ds_read_b64_tr_b16 v[98:99], v14 offset:4096
    v_xor_b32 v14, 96, v11
    ds_read_b64_tr_b16 v[100:101], v14 offset:0
    ds_read_b64_tr_b16 v[102:103], v14 offset:4096
    v_xor_b32 v14, 128, v11
    ds_read_b64_tr_b16 v[104:105], v14 offset:0
    ds_read_b64_tr_b16 v[106:107], v14 offset:4096
    v_xor_b32 v14, 160, v11
    ds_read_b64_tr_b16 v[108:109], v14 offset:0
    ds_read_b64_tr_b16 v[110:111], v14 offset:4096
    v_xor_b32 v14, 192, v11
    ds_read_b64_tr_b16 v[112:113], v14 offset:0
    ds_read_b64_tr_b16 v[114:115], v14 offset:4096
    v_xor_b32 v14, 224, v11
    ds_read_b64_tr_b16 v[116:117], v14 offset:0
    ds_read_b64_tr_b16 v[118:119], v14 offset:4096
    s_lshr_b32 s40, s35, 4
    s_lshl1_add_u32 s40, s34, s40
    s_lshl_b32 s40, s40, 5
    s_and_b32 s41, s35, 15
    s_add_u32 s40, s40, s41
    s_lshl_b32 s40, s40, 2
    s_add_u32 s95, s40, 0x148000
    s_mov_b32 s38, 0
Lkvdone_38:
    s_waitcnt vmcnt(6)
    v_xor_b32 v120, s37, v120
    v_xor_b32 v121, s37, v121
    v_xor_b32 v122, s37, v122
    v_xor_b32 v123, s37, v123
    v_or3_b32 v16, v120, v121, v122
    v_or_b32 v16, v16, v123
    v_xor_b32 v124, s37, v124
    v_xor_b32 v125, s37, v125
    v_xor_b32 v126, s37, v126
    v_xor_b32 v127, s37, v127
    v_or3_b32 v16, v16, v124, v125
    v_or3_b32 v16, v16, v126, v127
    s_waitcnt vmcnt(4)
    v_xor_b32 v128, s37, v128
    v_xor_b32 v129, s37, v129
    v_xor_b32 v130, s37, v130
    v_xor_b32 v131, s37, v131
    v_or3_b32 v16, v16, v128, v129
    v_or3_b32 v16, v16, v130, v131
    v_xor_b32 v132, s37, v132
    v_xor_b32 v133, s37, v133
    v_xor_b32 v134, s37, v134
    v_xor_b32 v135, s37, v135
    v_or3_b32 v16, v16, v132, v133
    v_or3_b32 v16, v16, v134, v135
    s_waitcnt vmcnt(2)
    v_xor_b32 v136, s37, v136
    v_xor_b32 v137, s37, v137
    v_xor_b32 v138, s37, v138
    v_xor_b32 v139, s37, v139
    v_or3_b32 v16, v16, v136, v137
    v_or3_b32 v16, v16, v138, v139
    v_xor_b32 v140, s37, v140
    v_xor_b32 v141, s37, v141
    v_xor_b32 v142, s37, v142
    v_xor_b32 v143, s37, v143
    v_or3_b32 v16, v16, v140, v141
    v_or3_b32 v16, v16, v142, v143
    s_waitcnt vmcnt(0)
    v_xor_b32 v144, s37, v144
    v_xor_b32 v145, s37, v145
    v_xor_b32 v146, s37, v146
    v_xor_b32 v147, s37, v147
    v_or3_b32 v16, v16, v144, v145
    v_or3_b32 v16, v16, v146, v147
    v_xor_b32 v148, s37, v148
    v_xor_b32 v149, s37, v149
    v_xor_b32 v150, s37, v150
    v_xor_b32 v151, s37, v151
    v_or3_b32 v16, v16, v148, v149
    v_or3_b32 v16, v16, v150, v151
    v_and_b32 v16, 0x3ff, v16
    v_cmp_ne_u32 vcc, 0, v16
    s_add_u32 s38, s38, 1
    s_cmp_gt_u32 s38, 1048576
    s_cbranch_scc1 L_end
    s_nop 1
    s_cbranch_vccnz Lgq_37
    v_pk_add_f32 v[120:121], v[120:121], v[124:125]
    v_pk_add_f32 v[122:123], v[122:123], v[126:127]
    v_pk_add_f32 v[128:129], v[128:129], v[132:133]
    v_pk_add_f32 v[130:131], v[130:131], v[134:135]
    v_pk_add_f32 v[136:137], v[136:137], v[140:141]
    v_pk_add_f32 v[138:139], v[138:139], v[142:143]
    v_pk_add_f32 v[144:145], v[144:145], v[148:149]
    v_pk_add_f32 v[146:147], v[146:147], v[150:151]
    v_pk_add_f32 v[120:121], v[120:121], v[128:129]
    v_pk_add_f32 v[122:123], v[122:123], v[130:131]
    v_pk_add_f32 v[136:137], v[136:137], v[144:145]
    v_pk_add_f32 v[138:139], v[138:139], v[146:147]
    v_pk_add_f32 v[120:121], v[120:121], v[136:137]
    v_pk_add_f32 v[122:123], v[122:123], v[138:139]
    v_cvt_pk_bf16_f32 v120, v120, v121
    v_cvt_pk_bf16_f32 v121, v122, v123
    s_mov_b32 s45, 0x3fb8aa3b
    ds_write_b64 v13, v[120:121] offset:6144
    s_mov_b64 exec, 1
    v_mov_b32 v1, 12044
    v_mov_b32 v2, 1
    ds_add_u32 v1, v2
    s_mov_b64 exec, -1
    v_mov_b32 v1, 12044
    s_mov_b32 s38, 0
Lspin_41:
    ds_read_b32 v2, v1
    ds_read_b128 v[152:155], v12 offset:6144
    ds_read_b128 v[156:159], v12 offset:6208
    ds_read_b128 v[160:163], v12 offset:6272
    ds_read_b128 v[164:167], v12 offset:6336
    ds_read_b32 v54, v1 offset:24
    s_add_u32 s38, s38, 1
    s_cmp_gt_u32 s38, 1048576
    s_cbranch_scc1 L_end
    s_waitcnt lgkmcnt(0)
    v_readfirstlane_b32 s39, v2
    s_cmp_eq_u32 s39, 4
    s_cbranch_scc0 Lspin_41
    v_readfirstlane_b32 s101, v54
    s_cmp_lg_u32 s101, 0
    s_cbranch_scc1 Lloc_43_d
    v_mov_b32 v1, 12068
    s_mov_b32 s38, 0
Lloc_43:
    ds_read_b32 v2, v1
    s_add_u32 s38, s38, 1
    s_cmp_gt_u32 s38, 1048576
    s_cbranch_scc1 L_end
    s_waitcnt lgkmcnt(0)
    v_readfirstlane_b32 s101, v2
    s_cmp_eq_u32 s101, 0
    s_cbranch_scc1 Lloc_43
Lloc_43_d:
    s_lshr_b32 s101, s101, 1
    v_mfma_f32_16x16x32_bf16 v[16:19], v[56:59], v[152:155], 0
    v_mfma_f32_16x16x32_bf16 v[20:23], v[72:75], v[152:155], 0
    v_mfma_f32_16x16x32_bf16 v[16:19], v[60:63], v[156:159], v[16:19]
    v_mfma_f32_16x16x32_bf16 v[20:23], v[76:79], v[156:159], v[20:23]
    v_mfma_f32_16x16x32_bf16 v[16:19], v[64:67], v[160:163], v[16:19]
    v_mfma_f32_16x16x32_bf16 v[20:23], v[80:83], v[160:163], v[20:23]
    v_mfma_f32_16x16x32_bf16 v[16:19], v[68:71], v[164:167], v[16:19]
    v_mfma_f32_16x16x32_bf16 v[20:23], v[84:87], v[164:167], v[20:23]
    s_nop 7
    v_cndmask_b32 v24, v16, v20, s[92:93]
    v_cndmask_b32 v25, v17, v21, s[92:93]
    v_cndmask_b32 v26, v18, v22, s[92:93]
    v_cndmask_b32 v27, v19, v23, s[92:93]
    v_cvt_pk_bf16_f32 v28, v24, v25
    v_cvt_pk_bf16_f32 v29, v26, v27
    v_lshlrev_b32 v24, 16, v28
    v_and_b32 v25, 0xffff0000, v28
    v_lshlrev_b32 v26, 16, v29
    v_and_b32 v27, 0xffff0000, v29
    v_pk_mul_f32 v[24:25], v[24:25], s[46:47]
    v_pk_mul_f32 v[26:27], v[26:27], s[46:47]
    v_cvt_pk_bf16_f32 v28, v24, v25
    v_cvt_pk_bf16_f32 v29, v26, v27
    v_lshlrev_b32 v24, 16, v28
    v_and_b32 v25, 0xffff0000, v28
    v_lshlrev_b32 v26, 16, v29
    v_and_b32 v27, 0xffff0000, v29
    v_max3_f32 v48, v24, v25, v26
    v_max_f32 v48, v48, v27
    s_nop 1
    v_max_f32_dpp v48, v48, v48 row_ror:8 row_mask:0xf bank_mask:0xf
    v_mov_b32 v50, v48
    s_nop 1
    v_permlane32_swap_b32 v50, v48
    v_max_f32 v48, v48, v50
    v_mov_b32 v50, v48
    s_nop 1
    v_permlane16_swap_b32 v50, v48
    v_max_f32 v48, v48, v50
    v_mul_f32 v50, s45, v48
    v_fma_f32 v24, v24, s45, -v50
    v_fma_f32 v25, v25, s45, -v50
    v_fma_f32 v26, v26, s45, -v50
    v_fma_f32 v27, v27, s45, -v50
    v_exp_f32 v24, v24
    v_exp_f32 v25, v25
    v_exp_f32 v26, v26
    v_exp_f32 v27, v27
    s_nop 0
    v_cvt_pk_bf16_f32 v32, v24, v25
    v_cvt_pk_bf16_f32 v33, v26, v27
    v_pk_add_f32 v[52:53], v[24:25], v[26:27]
    v_mov_b32_dpp v34, v32 row_ror:8 row_mask:0xf bank_mask:0xf
    v_mov_b32_dpp v35, v33 row_ror:8 row_mask:0xf bank_mask:0xf
    v_mov_b32 v36, v32
    v_mov_b32 v37, v33
    v_add_f32 v49, v52, v53
    v_mfma_f32_16x16x32_bf16 v[168:171], v[88:91], v[32:35], 0
    v_lshrrev_b32 v14, 1, v15
    v_add_f32_dpp v49, v49, v49 row_ror:8 row_mask:0xf bank_mask:0xf
    v_mfma_f32_16x16x32_bf16 v[172:175], v[92:95], v[34:37], 0
    v_mov_b32 v50, v49
    s_lshl_b32 s40, s3, 12
    v_mfma_f32_16x16x32_bf16 v[176:179], v[96:99], v[32:35], 0
    v_add_u32 v14, s40, v14
    v_permlane32_swap_b32 v50, v49
    v_mfma_f32_16x16x32_bf16 v[180:183], v[100:103], v[34:37], 0
    v_add_f32 v49, v49, v50
    v_mov_b32 v50, v49
    v_mfma_f32_16x16x32_bf16 v[184:187], v[104:107], v[32:35], 0
    s_nop 0
    v_mfma_f32_16x16x32_bf16 v[188:191], v[108:111], v[34:37], 0
    v_permlane16_swap_b32 v50, v49
    v_add_f32 v49, v49, v50
    v_mfma_f32_16x16x32_bf16 v[192:195], v[112:115], v[32:35], 0
    ds_write_b64 v14, v[48:49] offset:16384
    v_mfma_f32_16x16x32_bf16 v[196:199], v[116:119], v[34:37], 0
    v_cndmask_b32 v168, v168, v172, s[92:93]
    v_cndmask_b32 v169, v169, v173, s[92:93]
    v_cndmask_b32 v170, v170, v174, s[92:93]
    v_cndmask_b32 v171, v171, v175, s[92:93]
    ds_write_b128 v15, v[168:171] offset:12288
    v_cndmask_b32 v176, v176, v180, s[92:93]
    v_cndmask_b32 v177, v177, v181, s[92:93]
    v_cndmask_b32 v178, v178, v182, s[92:93]
    v_cndmask_b32 v179, v179, v183, s[92:93]
    ds_write_b128 v15, v[176:179] offset:13312
    v_cndmask_b32 v184, v184, v188, s[92:93]
    v_cndmask_b32 v185, v185, v189, s[92:93]
    v_cndmask_b32 v186, v186, v190, s[92:93]
    v_cndmask_b32 v187, v187, v191, s[92:93]
    ds_write_b128 v15, v[184:187] offset:14336
    v_cndmask_b32 v192, v192, v196, s[92:93]
    v_cndmask_b32 v193, v193, v197, s[92:93]
    v_cndmask_b32 v194, v194, v198, s[92:93]
    v_cndmask_b32 v195, v195, v199, s[92:93]
    ds_write_b128 v15, v[192:195] offset:15360
    s_mov_b64 exec, 1
    v_mov_b32 v1, 12040
    v_mov_b32 v2, 1
    ds_add_u32 v1, v2
    s_mov_b64 exec, -1
    v_lshlrev_b32 v14, 3, v0
    s_or_b32 s40, s101, s3
    s_cbranch_scc1 Lef_44
    s_mov_b32 s40, s95
    s_mov_b64 exec, 15
    v_mul_u32_u24 v1, 2176, v0
    v_add_u32 v1, s40, v1
    v_mov_b32 v2, s36
    global_store_dword v1, v2, s[26:27] sc1
    s_mov_b64 exec, -1
Lef_44:
    v_mov_b32 v1, 12040
    s_mov_b32 s38, 0
Lspin_45:
    ds_read_b32 v2, v1
    ds_read_b64 v[72:73], v14 offset:16384
    ds_read_b64 v[74:75], v14 offset:24576
    ds_read_b64 v[76:77], v14 offset:32768
    ds_read_b64 v[78:79], v14 offset:40960
    ds_read_b128 v[56:59], v10 offset:12288
    ds_read_b128 v[60:63], v10 offset:20480
    ds_read_b128 v[64:67], v10 offset:28672
    ds_read_b128 v[68:71], v10 offset:36864
    s_add_u32 s38, s38, 1
    s_cmp_gt_u32 s38, 1048576
    s_cbranch_scc1 L_end
    s_waitcnt lgkmcnt(0)
    v_readfirstlane_b32 s39, v2
    s_cmp_eq_u32 s39, 4
    s_cbranch_scc0 Lspin_45
    v_max3_f32 v48, v72, v74, v76
    v_max_f32 v48, v48, v78
    v_sub_f32 v72, v72, v48
    v_sub_f32 v74, v74, v48
    v_sub_f32 v76, v76, v48
    v_sub_f32 v78, v78, v48
    v_mul_f32 v72, s45, v72
    v_mul_f32 v74, s45, v74
    v_mul_f32 v76, s45, v76
    v_mul_f32 v78, s45, v78
    v_exp_f32 v72, v72
    v_exp_f32 v74, v74
    v_exp_f32 v76, v76
    v_exp_f32 v78, v78
    s_nop 0
    v_mul_f32 v49, v72, v73
    v_pk_mul_f32 v[16:17], v[56:57], v[72:73] op_sel_hi:[1,0]
    v_pk_mul_f32 v[18:19], v[58:59], v[72:73] op_sel_hi:[1,0]
    v_pk_fma_f32 v[16:17], v[60:61], v[74:75], v[16:17] op_sel_hi:[1,0,1]
    v_pk_fma_f32 v[18:19], v[62:63], v[74:75], v[18:19] op_sel_hi:[1,0,1]
    v_fmac_f32 v49, v74, v75
    v_pk_fma_f32 v[16:17], v[64:65], v[76:77], v[16:17] op_sel_hi:[1,0,1]
    v_pk_fma_f32 v[18:19], v[66:67], v[76:77], v[18:19] op_sel_hi:[1,0,1]
    v_fmac_f32 v49, v76, v77
    v_pk_fma_f32 v[16:17], v[68:69], v[78:79], v[16:17] op_sel_hi:[1,0,1]
    v_pk_fma_f32 v[18:19], v[70:71], v[78:79], v[18:19] op_sel_hi:[1,0,1]
    v_fmac_f32 v49, v78, v79
    v_bfi_b32 v16, s44, v3, v16
    v_bfi_b32 v17, s44, v3, v17
    v_bfi_b32 v18, s44, v3, v18
    v_bfi_b32 v19, s44, v3, v19
    s_cmp_lg_u32 s101, 0
    s_cbranch_scc1 Lremote_48
    global_store_dwordx4 v8, v[16:19], s[26:27]
    s_cmp_lg_u32 s3, 0
    s_cbranch_scc1 Lnoml_47
    v_bfi_b32 v48, s44, v3, v48
    v_bfi_b32 v49, s44, v3, v49
    v_mov_b32 v50, v3
    v_mov_b32 v51, v3
    s_mov_b64 exec, 0xff
    global_store_dwordx4 v9, v[48:51], s[26:27]
    s_branch Lflagb_49
Lremote_48:
    global_store_dwordx4 v8, v[16:19], s[26:27] sc1
    s_cmp_lg_u32 s3, 0
    s_cbranch_scc1 Lnoml_47
    v_bfi_b32 v48, s44, v3, v48
    v_bfi_b32 v49, s44, v3, v49
    v_mov_b32 v50, v3
    v_mov_b32 v51, v3
    s_mov_b64 exec, 0xff
    global_store_dwordx4 v9, v[48:51], s[26:27] sc1
Lflagb_49:
    s_mov_b64 exec, -1
    s_cmp_eq_u32 s101, 0
    s_cbranch_scc1 Lnoml_47
    s_mov_b32 s40, s95
    s_mov_b64 exec, 15
    v_mul_u32_u24 v1, 2176, v0
    v_add_u32 v1, s40, v1
    v_mov_b32 v2, s36
    global_store_dword v1, v2, s[26:27] sc1
    s_mov_b64 exec, -1
Lnoml_47:
    s_and_b32 s40, s33, 7
    s_lshl2_add_u32 s41, s40, s3
    s_lshl_b32 s41, s41, 7
    s_mul_i32 s42, s34, 135168
    s_add_u32 s41, s41, s42
    s_add_u32 s41, s41, 0xa0000
    v_lshrrev_b32 v1, 3, v0
    v_mul_u32_u24 v1, 4224, v1
    v_and_b32 v2, 7, v0
    v_lshl_add_u32 v1, v2, 4, v1
    v_add_u32 v6, s41, v1
    v_add_u32 v13, 33792, v6
    v_add_u32 v14, 67584, v6
    v_add_u32 v15, 101376, v6
    s_lshl_b32 s41, s34, 8
    s_add_u32 s40, s40, s41
    s_lshl_b32 s40, s40, 4
    s_add_u32 s40, s40, 0x4000
    v_and_b32 v1, 31, v0
    v_lshl_add_u32 v7, v1, 7, s40
    s_lshl_b32 s40, s3, 7
    v_and_b32 v2, 7, v0
    v_lshrrev_b32 v1, 3, v1
    v_lshl_add_u32 v1, v1, 2, s40
    v_lshl_add_u32 v10, v2, 4, v1
    v_lshrrev_b32 v1, 3, v0
    v_lshl_add_u32 v11, v1, 4, s40
    v_and_b32 v1, 1, v0
    v_lshl_add_u32 v1, v1, 2, v5
    v_and_b32 v2, 6, v0
    v_lshl_add_u32 v12, v1, 5, v2
    s_lshl_b32 s40, s3, 3
    v_add_u32 v12, s40, v12
    s_cmp_ge_u32 s3, 2
    s_cbranch_scc1 Lnopollb_50
    s_and_b32 s40, s35, 3
    s_mul_i32 s40, s40, 2176
    s_lshl1_add_u32 s41, s34, s3
    s_lshl_b32 s41, s41, 7
    s_add_u32 s40, s40, s41
    s_add_u32 s40, s40, 0x148000
    s_mov_b32 s38, 0
    s_mov_b32 s42, s36
    s_mov_b32 s43, s36
    s_branch Lpoll_51
Lretry_52:
    s_sleep 1
Lpoll_51:
    s_load_dwordx16 s[48:63], s[26:27], s40 glc
    s_add_u32 s38, s38, 1
    s_cmp_gt_u32 s38, 1048576
    s_cbranch_scc1 L_end
    s_waitcnt lgkmcnt(0)
    s_cmp_eq_u64 s[48:49], s[42:43]
    s_cbranch_scc0 Lretry_52
    s_cmp_eq_u64 s[50:51], s[42:43]
    s_cbranch_scc0 Lretry_52
    s_cmp_eq_u64 s[52:53], s[42:43]
    s_cbranch_scc0 Lretry_52
    s_cmp_eq_u64 s[54:55], s[42:43]
    s_cbranch_scc0 Lretry_52
    s_cmp_eq_u64 s[56:57], s[42:43]
    s_cbranch_scc0 Lretry_52
    s_cmp_eq_u64 s[58:59], s[42:43]
    s_cbranch_scc0 Lretry_52
    s_cmp_eq_u64 s[60:61], s[42:43]
    s_cbranch_scc0 Lretry_52
    s_cmp_eq_u64 s[62:63], s[42:43]
    s_cbranch_scc0 Lretry_52
Lflag_53:
    s_mov_b64 exec, 1
    v_mov_b32 v1, 12060
    v_mov_b32 v2, 1
    ds_add_u32 v1, v2
    s_mov_b64 exec, -1
Lnopollb_50:
    v_mov_b32 v1, 12060
    s_mov_b32 s38, 0
Lspin_54:
    ds_read_b32 v2, v1
    s_add_u32 s38, s38, 1
    s_cmp_gt_u32 s38, 1048576
    s_cbranch_scc1 L_end
    s_waitcnt lgkmcnt(0)
    v_readfirstlane_b32 s39, v2
    s_cmp_eq_u32 s39, 2
    s_cbranch_scc0 Lspin_54
    s_mov_b32 s47, 0
Lgo_56:
    s_cmp_lg_u32 s101, 0
    s_cbranch_scc1 Lremote_57
    global_load_dwordx4 v[72:75], v7, s[26:27] nt
    global_load_dwordx4 v[56:59], v6, s[26:27] nt
    global_load_dwordx4 v[60:63], v13, s[26:27] nt
    global_load_dwordx4 v[64:67], v14, s[26:27] nt
    global_load_dwordx4 v[68:71], v15, s[26:27] nt
    s_branch Lbld_58
Lremote_57:
    global_load_dwordx4 v[72:75], v7, s[26:27] sc1
    global_load_dwordx4 v[56:59], v6, s[26:27] sc1
    global_load_dwordx4 v[60:63], v13, s[26:27] sc1
    global_load_dwordx4 v[64:67], v14, s[26:27] sc1
    global_load_dwordx4 v[68:71], v15, s[26:27] sc1
Lbld_58:
    s_mov_b32 s101, 1
    s_cmp_lg_u32 s47, 0
    s_cbranch_scc1 Lhb_59
    s_mov_b32 s47, 1
    s_mov_b64 exec, 1
    v_mov_b32 v1, 12048
    v_mov_b32 v2, 1
    ds_add_u32 v1, v2
    s_mov_b64 exec, -1
Lhb_59:
    s_waitcnt vmcnt(4)
    v_xor_b32 v72, s37, v72
    v_xor_b32 v73, s37, v73
    v_xor_b32 v74, s37, v74
    v_xor_b32 v75, s37, v75
    v_or3_b32 v32, v72, v73, v74
    v_or_b32 v32, v32, v75
    v_mov_b32 v16, v72
    s_waitcnt vmcnt(0)
    v_xor_b32 v56, s37, v56
    v_xor_b32 v57, s37, v57
    v_max_f32_dpp v16, v16, v16 quad_perm:[1,0,3,2] row_mask:0xf bank_mask:0xf
    v_xor_b32 v58, s37, v58
    v_xor_b32 v59, s37, v59
    v_max_f32_dpp v16, v16, v16 quad_perm:[2,3,0,1] row_mask:0xf bank_mask:0xf
    v_or3_b32 v32, v32, v56, v57
    v_or3_b32 v32, v32, v58, v59
    v_max_f32_dpp v16, v16, v16 row_half_mirror row_mask:0xf bank_mask:0xf
    v_xor_b32 v60, s37, v60
    v_xor_b32 v61, s37, v61
    v_max_f32_dpp v16, v16, v16 row_mirror row_mask:0xf bank_mask:0xf
    v_mov_b32 v18, v16
    v_xor_b32 v62, s37, v62
    v_xor_b32 v63, s37, v63
    v_permlane16_swap_b32 v18, v16
    v_max_f32 v16, v16, v18
    v_sub_f32 v20, v72, v16
    v_mul_f32 v20, s45, v20
    v_exp_f32 v20, v20
    s_mov_b32 exec_hi, 0
    ds_write_b32 v10, v20 offset:8448
    s_mov_b32 exec_hi, -1
    ds_read_b128 v[24:27], v11 offset:8448
    v_mul_f32 v17, v20, v73
    v_or3_b32 v32, v32, v60, v61
    v_or3_b32 v32, v32, v62, v63
    v_add_f32_dpp v17, v17, v17 quad_perm:[1,0,3,2] row_mask:0xf bank_mask:0xf
    v_xor_b32 v64, s37, v64
    v_xor_b32 v65, s37, v65
    v_add_f32_dpp v17, v17, v17 quad_perm:[2,3,0,1] row_mask:0xf bank_mask:0xf
    v_xor_b32 v66, s37, v66
    v_xor_b32 v67, s37, v67
    v_add_f32_dpp v17, v17, v17 row_half_mirror row_mask:0xf bank_mask:0xf
    v_or3_b32 v32, v32, v64, v65
    v_or3_b32 v32, v32, v66, v67
    v_add_f32_dpp v17, v17, v17 row_mirror row_mask:0xf bank_mask:0xf
    v_mov_b32 v18, v17
    v_xor_b32 v68, s37, v68
    v_xor_b32 v69, s37, v69
    v_permlane16_swap_b32 v18, v17
    v_add_f32 v17, v17, v18
    v_rcp_f32 v17, v17
    v_xor_b32 v70, s37, v70
    v_xor_b32 v71, s37, v71
    v_or3_b32 v32, v32, v68, v69
    v_or3_b32 v32, v32, v70, v71
    v_and_b32 v32, 0x3ff, v32
    v_cmp_ne_u32 vcc, 0, v32
    s_add_u32 s38, s38, 1
    s_cmp_gt_u32 s38, 1048576
    s_cbranch_scc1 L_end
    s_nop 1
    s_cbranch_vccnz Lgo_56
    s_waitcnt lgkmcnt(0)
    v_pk_mul_f32 v[20:21], v[56:57], v[24:25] op_sel:[0,0] op_sel_hi:[1,0]
    v_pk_mul_f32 v[22:23], v[58:59], v[24:25] op_sel:[0,0] op_sel_hi:[1,0]
    v_pk_fma_f32 v[20:21], v[60:61], v[24:25], v[20:21] op_sel:[0,1,0] op_sel_hi:[1,1,1]
    v_pk_fma_f32 v[22:23], v[62:63], v[24:25], v[22:23] op_sel:[0,1,0] op_sel_hi:[1,1,1]
    v_pk_fma_f32 v[20:21], v[64:65], v[26:27], v[20:21] op_sel:[0,0,0] op_sel_hi:[1,0,1]
    v_pk_fma_f32 v[22:23], v[66:67], v[26:27], v[22:23] op_sel:[0,0,0] op_sel_hi:[1,0,1]
    v_pk_fma_f32 v[20:21], v[68:69], v[26:27], v[20:21] op_sel:[0,1,0] op_sel_hi:[1,1,1]
    v_pk_fma_f32 v[22:23], v[70:71], v[26:27], v[22:23] op_sel:[0,1,0] op_sel_hi:[1,1,1]
    s_nop 1
    v_permlane32_swap_b32 v20, v22
    v_permlane32_swap_b32 v21, v23
    v_add_f32 v20, v20, v22
    v_add_f32 v21, v21, v23
    s_nop 1
    v_permlane16_swap_b32 v20, v21
    v_add_f32 v20, v20, v21
    s_nop 1
    v_add_f32_dpp v20, v20, v20 row_ror:8 row_mask:0xf bank_mask:0xf
    v_mov_b32 v1, 12052
    v_mul_f32 v20, v20, v17
    v_mov_b32 v2, 1
    v_cvt_pk_bf16_f32 v20, v20, v20
    s_mov_b32 exec_lo, 0xff00ff
    s_mov_b32 exec_hi, 0xff00ff
    ds_write_b16 v12, v20 offset:8960
    s_mov_b64 exec, 1
    ds_add_u32 v1, v2
    s_mov_b64 exec, -1
L_adone:
    s_endpgm
L_ffn:
    s_cmp_eq_u32 s3, 2
    s_cbranch_scc0 L_adone
    v_lshlrev_b32 v10, 4, v0
    s_sub_u32 s41, s98, s33
    s_lshl2_add_u32 s40, s33, s30
    s_lshl_b32 s40, s40, 10
    s_add_u32 s40, s40, 0x30000
    v_add_u32 v11, s40, v10
    v_lshrrev_b32 v13, 5, v0
    s_lshl_b32 s42, s41, 12
    v_mul_lo_u32 v12, s42, v13
    v_add_u32 v11, v11, v12
    s_lshl_b32 s40, s33, 5
    s_add_u32 s40, s40, s30
    s_lshl_b32 s40, s40, 2
    s_lshl_b32 s42, s41, 7
    s_add_u32 s42, s42, 16
    v_mul_lo_u32 v12, s42, v0
    v_add_u32 v12, s40, v12
    s_movk_i32 s40, 0x1000
    v_mov_b32 v1, 12036
    s_mov_b32 s38, 0
Lspin_60:
    ds_read_b32 v2, v1
    ds_read_b128 v[16:19], v10 offset:2048
    ds_read_b128 v[20:23], v10 offset:3072
    ds_read_b128 v[24:27], v10 offset:4096
    ds_read_b128 v[28:31], v10 offset:5120
    s_add_u32 s38, s38, 1
    s_cmp_gt_u32 s38, 1048576
    s_cbranch_scc1 L_end
    s_waitcnt lgkmcnt(0)
    v_readfirstlane_b32 s39, v2
    s_cmp_eq_u32 s39, 4
    s_cbranch_scc1 Lgot_61
    s_sleep 1
    s_branch Lspin_60
Lgot_61:
    v_pk_add_f32 v[16:17], v[16:17], v[20:21]
    v_pk_add_f32 v[24:25], v[24:25], v[28:29]
    v_pk_add_f32 v[18:19], v[18:19], v[22:23]
    v_pk_add_f32 v[26:27], v[26:27], v[30:31]
    v_pk_add_f32 v[16:17], v[16:17], v[24:25]
    v_pk_add_f32 v[18:19], v[18:19], v[26:27]
    v_add_u32 v16, 0x200, v16
    v_add_u32 v17, 0x200, v17
    v_add_u32 v18, 0x200, v18
    v_add_u32 v19, 0x200, v19
    v_bfi_b32 v16, s44, v3, v16
    v_bfi_b32 v17, s44, v3, v17
    v_bfi_b32 v18, s44, v3, v18
    v_bfi_b32 v19, s44, v3, v19
    global_store_dwordx4 v11, v[16:19], s[26:27] sc1
    s_mov_b64 exec, 3
    v_add_u32 v1, s40, v12
    v_mov_b32 v2, s36
    global_store_dword v1, v2, s[26:27] sc1
    s_mov_b64 exec, -1
    s_lshl_b32 s40, s33, 12
    s_add_u32 s40, s40, 0x30000
    v_add_u32 v6, s40, v10
    v_and_b32 v1, 1, v0
    v_lshl_add_u32 v1, v1, 1, v13
    v_and_b32 v2, 30, v0
    v_lshl_add_u32 v12, v1, 6, v2
    s_lshl_b32 s40, s33, 7
    s_add_u32 s40, s40, 0x1000
    s_mov_b32 s38, 0
    s_mov_b32 s42, s36
    s_mov_b32 s43, s36
    s_branch Lpoll_62
Lretry_63:
    s_sleep 1
Lpoll_62:
    s_load_dwordx8 s[48:55], s[26:27], s40 glc
    s_add_u32 s38, s38, 1
    s_cmp_gt_u32 s38, 1048576
    s_cbranch_scc1 L_end
    s_waitcnt lgkmcnt(0)
    s_cmp_eq_u64 s[48:49], s[42:43]
    s_cbranch_scc0 Lretry_63
    s_cmp_eq_u64 s[50:51], s[42:43]
    s_cbranch_scc0 Lretry_63
    s_cmp_eq_u64 s[52:53], s[42:43]
    s_cbranch_scc0 Lretry_63
    s_cmp_eq_u64 s[54:55], s[42:43]
    s_cbranch_scc0 Lretry_63
Lflag_64:
    s_mov_b32 s47, 0
Lgd_65:
    global_load_dwordx4 v[56:59], v6, s[26:27] offset:0 sc1
    global_load_dwordx4 v[60:63], v6, s[26:27] offset:1024 sc1
    global_load_dwordx4 v[64:67], v6, s[26:27] offset:2048 sc1
    global_load_dwordx4 v[68:71], v6, s[26:27] offset:3072 sc1
    s_cmp_lg_u32 s47, 0
    s_cbranch_scc1 Lhb_66
    s_mov_b32 s47, 1
    s_mov_b64 exec, 1
    v_mov_b32 v1, 12048
    v_mov_b32 v2, 1
    ds_add_u32 v1, v2
    s_mov_b64 exec, -1
Lhb_66:
    s_waitcnt vmcnt(2)
    v_xor_b32 v56, s37, v56
    v_xor_b32 v57, s37, v57
    v_xor_b32 v58, s37, v58
    v_xor_b32 v59, s37, v59
    v_or3_b32 v16, v56, v57, v58
    v_or_b32 v16, v16, v59
    v_xor_b32 v60, s37, v60
    v_xor_b32 v61, s37, v61
    v_xor_b32 v62, s37, v62
    v_xor_b32 v63, s37, v63
    v_or3_b32 v16, v16, v60, v61
    v_or3_b32 v16, v16, v62, v63
    s_waitcnt vmcnt(0)
    v_xor_b32 v64, s37, v64
    v_xor_b32 v65, s37, v65
    v_xor_b32 v66, s37, v66
    v_xor_b32 v67, s37, v67
    v_or3_b32 v16, v16, v64, v65
    v_or3_b32 v16, v16, v66, v67
    v_xor_b32 v68, s37, v68
    v_xor_b32 v69, s37, v69
    v_xor_b32 v70, s37, v70
    v_xor_b32 v71, s37, v71
    v_or3_b32 v16, v16, v68, v69
    v_or3_b32 v16, v16, v70, v71
    v_and_b32 v16, 0x3ff, v16
    v_cmp_ne_u32 vcc, 0, v16
    s_add_u32 s38, s38, 1
    s_cmp_gt_u32 s38, 1048576
    s_cbranch_scc1 L_end
    s_nop 1
    s_cbranch_vccnz Lgd_65
    v_pk_add_f32 v[56:57], v[56:57], v[60:61]
    v_pk_add_f32 v[64:65], v[64:65], v[68:69]
    v_pk_add_f32 v[58:59], v[58:59], v[62:63]
    v_pk_add_f32 v[66:67], v[66:67], v[70:71]
    v_pk_add_f32 v[56:57], v[56:57], v[64:65]
    v_pk_add_f32 v[58:59], v[58:59], v[66:67]
    v_cvt_pk_bf16_f32 v56, v56, v57
    v_cvt_pk_bf16_f32 v57, v58, v59
    s_mov_b32 s46, 0xbdd2d3e8
    v_mov_b32 v20, 0xc0135761
    v_permlane32_swap_b32 v56, v57
    v_lshlrev_b32 v58, 16, v56
    v_and_b32 v59, 0xffff0000, v56
    v_pk_mul_f32 v[16:17], v[58:59], v[58:59]
    v_fma_f32 v16, v16, s46, v20
    v_fma_f32 v17, v17, s46, v20
    v_pk_mul_f32 v[16:17], v[16:17], v[58:59]
    v_exp_f32 v16, v16
    v_exp_f32 v17, v17
    v_lshlrev_b32 v60, 16, v57
    v_add_f32 v16, 1.0, v16
    v_add_f32 v17, 1.0, v17
    v_rcp_f32 v16, v16
    v_rcp_f32 v17, v17
    v_and_b32 v61, 0xffff0000, v57
    v_pk_mul_f32 v[58:59], v[58:59], v[16:17]
    v_cvt_pk_bf16_f32 v56, v58, v59
    v_lshlrev_b32 v58, 16, v56
    v_and_b32 v59, 0xffff0000, v56
    v_pk_mul_f32 v[58:59], v[58:59], v[60:61]
    v_mov_b32 v1, 12052
    v_cvt_pk_bf16_f32 v56, v58, v59
    v_mov_b32 v2, 1
    ds_write_b16 v12, v56 offset:8960
    ds_write_b16_d16_hi v12, v56 offset:8992
    s_mov_b64 exec, 1
    ds_write_b32 v1, v2
    s_mov_b64 exec, -1
    s_branch L_adone
L_sdispatch:
    s_lshl_b32 s40, s34, 24
    s_lshl_b32 s41, s35, 15
    s_add_u32 s40, s40, s41
    s_lshl_b32 s47, s3, 13
    s_add_u32 s40, s40, s47
    s_add_u32 s47, s47, 12288
    s_add_u32 s40, s40, 0xf00000
    v_xor_b32 v1, v4, v5
    v_lshlrev_b32 v1, 4, v1
    v_lshl_add_u32 v1, v5, 8, v1
    v_add_u32 v7, s40, v1
    v_lshlrev_b32 v1, 1, v5
    v_xor_b32 v1, v4, v1
    v_lshlrev_b32 v1, 4, v1
    v_lshl_add_u32 v1, v5, 8, v1
    v_add_u32 v8, s40, v1
    s_waitcnt vmcnt(5)
    s_mov_b32 m0, s47
    v_xor_b32 v1, 0, v7
    global_load_lds_dwordx4 v1, s[6:7] offset:0 nt
    s_waitcnt vmcnt(5)
    v_xor_b32 v1, 64, v7
    global_load_lds_dwordx4 v1, s[6:7] offset:1024 nt
    s_waitcnt vmcnt(5)
    v_xor_b32 v1, 128, v7
    global_load_lds_dwordx4 v1, s[6:7] offset:2048 nt
    s_lshl_b32 s41, s3, 2
    s_add_u32 s41, s41, 12080
    v_mov_b32 v1, s41
    s_mov_b32 s38, 0
Lspin_1:
    ds_read_b32 v2, v1
    s_add_u32 s38, s38, 1
    s_cmp_gt_u32 s38, 1048576
    s_cbranch_scc1 L_end
    s_waitcnt lgkmcnt(0)
    v_readfirstlane_b32 s39, v2
    s_cmp_eq_u32 s39, 1
    s_cbranch_scc0 Lspin_1
    s_lshl_b32 s40, s3, 6
    v_lshl_add_u32 v2, v5, 4, s40
    ds_read_b128 v[24:27], v2 offset:9216
    s_waitcnt lgkmcnt(0)
    v_perm_b32 v36, v24, v24, v16
    v_perm_b32 v37, v24, v24, v17
    v_perm_b32 v38, v24, v24, v18
    v_perm_b32 v39, v24, v24, v19
    s_nop 1
    v_mfma_f32_16x16x32_bf16 v[40:43], v[36:39], v[56:59], 0
    v_perm_b32 v36, v24, v24, v20
    v_perm_b32 v37, v24, v24, v21
    v_perm_b32 v38, v24, v24, v22
    v_perm_b32 v39, v24, v24, v23
    s_nop 1
    v_mfma_f32_16x16x32_bf16 v[40:43], v[36:39], v[60:63], v[40:43]
    v_perm_b32 v36, v25, v25, v16
    v_perm_b32 v37, v25, v25, v17
    v_perm_b32 v38, v25, v25, v18
    v_perm_b32 v39, v25, v25, v19
    s_nop 1
    v_mfma_f32_16x16x32_bf16 v[40:43], v[36:39], v[64:67], v[40:43]
    v_perm_b32 v36, v25, v25, v20
    v_perm_b32 v37, v25, v25, v21
    v_perm_b32 v38, v25, v25, v22
    v_perm_b32 v39, v25, v25, v23
    s_nop 1
    v_mfma_f32_16x16x32_bf16 v[40:43], v[36:39], v[68:71], v[40:43]
    v_perm_b32 v36, v26, v26, v16
    v_perm_b32 v37, v26, v26, v17
    v_perm_b32 v38, v26, v26, v18
    v_perm_b32 v39, v26, v26, v19
    s_nop 1
    v_mfma_f32_16x16x32_bf16 v[40:43], v[36:39], v[72:75], v[40:43]
    v_perm_b32 v36, v26, v26, v20
    v_perm_b32 v37, v26, v26, v21
    v_perm_b32 v38, v26, v26, v22
    v_perm_b32 v39, v26, v26, v23
    s_nop 1
    s_waitcnt vmcnt(7)
    v_xor_b32 v1, 192, v7
    global_load_lds_dwordx4 v1, s[6:7] offset:3072 nt
    s_waitcnt vmcnt(7)
    s_add_u32 s47, s47, 4096
    s_mov_b32 m0, s47
    v_add_u32 v7, 4096, v7
    v_xor_b32 v1, 0, v7
    global_load_lds_dwordx4 v1, s[6:7] offset:0 nt
    s_waitcnt vmcnt(7)
    v_xor_b32 v1, 64, v7
    global_load_lds_dwordx4 v1, s[6:7] offset:1024 nt
    v_mfma_f32_16x16x32_bf16 v[40:43], v[36:39], v[76:79], v[40:43]
    v_perm_b32 v36, v27, v27, v16
    v_perm_b32 v37, v27, v27, v17
    v_perm_b32 v38, v27, v27, v18
    v_perm_b32 v39, v27, v27, v19
    s_nop 1
    s_waitcnt vmcnt(7)
    v_xor_b32 v1, 128, v7
    global_load_lds_dwordx4 v1, s[6:7] offset:2048 nt
    v_mfma_f32_16x16x32_bf16 v[40:43], v[36:39], v[80:83], v[40:43]
    v_perm_b32 v36, v27, v27, v20
    v_perm_b32 v37, v27, v27, v21
    v_perm_b32 v38, v27, v27, v22
    v_perm_b32 v39, v27, v27, v23
    s_nop 1
    s_waitcnt vmcnt(7)
    v_xor_b32 v1, 192, v7
    global_load_lds_dwordx4 v1, s[6:7] offset:3072 nt
    v_mfma_f32_16x16x32_bf16 v[40:43], v[36:39], v[84:87], v[40:43]
    s_nop 4
    s_lshl_b32 s40, s3, 9
    v_add_u32 v1, s40, v11
    s_mov_b32 exec_hi, 0
    ds_write_b128 v1, v[40:43] offset:0
    s_mov_b64 exec, 1
    v_mov_b32 v1, 12032
    v_mov_b32 v2, 1
    ds_add_u32 v1, v2
    s_mov_b64 exec, -1
    s_waitcnt vmcnt(7)
    s_add_u32 s47, s47, 28672
    s_mov_b32 m0, s47
    v_xor_b32 v1, 0, v8
    global_load_lds_dwordx4 v1, s[8:9] offset:0 nt
    s_waitcnt vmcnt(7)
    v_xor_b32 v1, 128, v8
    global_load_lds_dwordx4 v1, s[8:9] offset:1024 nt
    s_waitcnt vmcnt(7)
    v_xor_b32 v1, 0, v8
    global_load_lds_dwordx4 v1, s[8:9] offset:2048 nt
    s_waitcnt vmcnt(7)
    v_xor_b32 v1, 128, v8
    global_load_lds_dwordx4 v1, s[8:9] offset:3072 nt
    s_waitcnt vmcnt(7)
    s_add_u32 s47, s47, 4096
    s_mov_b32 m0, s47
    v_add_u32 v8, 4096, v8
    v_xor_b32 v1, 0, v8
    global_load_lds_dwordx4 v1, s[8:9] offset:0 nt
    s_waitcnt vmcnt(7)
    v_xor_b32 v1, 128, v8
    global_load_lds_dwordx4 v1, s[8:9] offset:1024 nt
    s_waitcnt vmcnt(7)
    v_xor_b32 v1, 0, v8
    global_load_lds_dwordx4 v1, s[8:9] offset:2048 nt
    s_waitcnt vmcnt(7)
    v_xor_b32 v1, 128, v8
    global_load_lds_dwordx4 v1, s[8:9] offset:3072 nt
    s_lshl_b32 s40, s3, 2
    s_mov_b64 exec, 1
    v_mov_b32 v1, s40
    v_mov_b32 v2, 1
    ds_write_b32 v1, v2 offset:12096
    s_mov_b64 exec, -1
Lkvf_3:
    s_mov_b32 s43, 0
    v_mov_b32 v1, 12056
    ds_read_b32 v2, v1
    s_waitcnt lgkmcnt(0)
    v_readfirstlane_b32 s39, v2
    s_cmp_eq_u32 s39, 4
    s_cbranch_scc1 Lgo_4
    s_waitcnt vmcnt(0)
    s_mov_b32 s43, 1
    s_lshl_b32 s40, s3, 2
    s_mov_b64 exec, 1
    v_mov_b32 v1, s40
    v_mov_b32 v2, 1
    ds_write_b32 v1, v2 offset:12112
    s_mov_b64 exec, -1
    v_mov_b32 v1, 12056
    s_mov_b32 s38, 0
Lspin_5:
    ds_read_b32 v2, v1
    s_add_u32 s38, s38, 1
    s_cmp_gt_u32 s38, 1048576
    s_cbranch_scc1 L_end
    s_waitcnt lgkmcnt(0)
    v_readfirstlane_b32 s39, v2
    s_cmp_eq_u32 s39, 4
    s_cbranch_scc1 Lgot_6
    s_sleep 1
    s_branch Lspin_5
Lgot_6:
Lgo_4:
    s_waitcnt vmcnt(2)
    global_load_dwordx4 v[120:123], v10, s[12:13] nt
    v_add_u32 v10, s45, v10
    s_waitcnt vmcnt(2)
    global_load_dwordx4 v[124:127], v10, s[12:13] nt
    v_add_u32 v10, s45, v10
    s_waitcnt vmcnt(2)
    global_load_dwordx4 v[128:131], v10, s[12:13] nt
    v_add_u32 v10, s45, v10
    s_cmp_lg_u32 s43, 0
    s_cbranch_scc1 Lkvf_8
    s_lshl_b32 s40, s3, 2
    s_mov_b64 exec, 1
    v_mov_b32 v1, s40
    v_mov_b32 v2, 1
    ds_write_b32 v1, v2 offset:12112
    s_mov_b64 exec, -1
Lkvf_8:
    s_waitcnt vmcnt(2)
    global_load_dwordx4 v[132:135], v10, s[12:13] nt
    v_add_u32 v10, s45, v10
    s_waitcnt vmcnt(2)
    global_load_dwordx4 v[136:139], v10, s[12:13] nt
    v_add_u32 v10, s45, v10
    s_waitcnt vmcnt(2)
    global_load_dwordx4 v[140:143], v10, s[12:13] nt
    v_add_u32 v10, s45, v10
    s_waitcnt vmcnt(2)
    global_load_dwordx4 v[144:147], v10, s[12:13] nt
    v_add_u32 v10, s45, v10
    s_waitcnt vmcnt(2)
    global_load_dwordx4 v[148:151], v10, s[12:13] nt
    v_add_u32 v10, s45, v10
    s_waitcnt vmcnt(7)
    global_load_dwordx4 v[152:155], v10, s[12:13] nt
    v_add_u32 v10, s45, v10
    s_waitcnt vmcnt(7)
    global_load_dwordx4 v[156:159], v10, s[12:13] nt
    v_add_u32 v10, s45, v10
    s_waitcnt vmcnt(7)
    global_load_dwordx4 v[160:163], v10, s[12:13] nt
    v_add_u32 v10, s45, v10
    s_waitcnt vmcnt(7)
    global_load_dwordx4 v[164:167], v10, s[12:13] nt
    v_add_u32 v10, s45, v10
    v_mov_b32 v1, 12048
    s_mov_b32 s38, 0
Lspin_9:
    ds_read_b32 v2, v1
    s_add_u32 s38, s38, 1
    s_cmp_gt_u32 s38, 1048576
    s_cbranch_scc1 L_end
    s_waitcnt lgkmcnt(0)
    v_readfirstlane_b32 s39, v2
    s_cmp_eq_u32 s39, 4
    s_cbranch_scc1 Lgot_10
    s_sleep 1
    s_branch Lspin_9
Lgot_10:
    s_waitcnt vmcnt(7)
    global_load_dwordx4 v[168:171], v10, s[12:13] nt
    v_add_u32 v10, s45, v10
    s_waitcnt vmcnt(7)
    global_load_dwordx4 v[172:175], v10, s[12:13] nt
    v_add_u32 v10, s45, v10
    s_waitcnt vmcnt(7)
    global_load_dwordx4 v[176:179], v10, s[12:13] nt
    v_add_u32 v10, s45, v10
    s_waitcnt vmcnt(7)
    global_load_dwordx4 v[180:183], v10, s[12:13] nt
    v_lshlrev_b32 v15, 5, v12
    s_mul_i32 s40, s33, 4352
    s_add_u32 s40, s40, 0x50000
    v_add_u32 v14, s40, v14
    v_mov_b32 v1, 12052
    s_mov_b32 s38, 0
Lspin_11:
    ds_read_b32 v2, v1
    ds_read_b128 v[28:31], v15 offset:8960
    ds_read_b128 v[32:35], v15 offset:8976
    s_add_u32 s38, s38, 1
    s_cmp_gt_u32 s38, 1048576
    s_cbranch_scc1 L_end
    s_waitcnt lgkmcnt(0)
    v_readfirstlane_b32 s39, v2
    s_cmp_eq_u32 s39, 4
    s_cbranch_scc0 Lspin_11
.p2align 3
    v_perm_b32 v56, v28, v28, v16
    v_perm_b32 v57, v28, v28, v17
    v_perm_b32 v58, v28, v28, v18
    v_perm_b32 v59, v28, v28, v19
    v_perm_b32 v60, v28, v28, v20
    v_perm_b32 v61, v28, v28, v21
    v_perm_b32 v62, v28, v28, v22
    v_perm_b32 v63, v28, v28, v23
    v_mfma_f32_16x16x32_bf16 v[40:43], v[56:59], v[120:123], 0
    v_perm_b32 v64, v29, v29, v16
    v_perm_b32 v65, v29, v29, v17
    v_perm_b32 v66, v29, v29, v18
    v_perm_b32 v67, v29, v29, v19
    v_mfma_f32_16x16x32_bf16 v[40:43], v[60:63], v[124:127], v[40:43]
    v_perm_b32 v68, v29, v29, v20
    v_perm_b32 v69, v29, v29, v21
    v_perm_b32 v70, v29, v29, v22
    v_perm_b32 v71, v29, v29, v23
    v_mfma_f32_16x16x32_bf16 v[40:43], v[64:67], v[128:131], v[40:43]
    v_perm_b32 v72, v30, v30, v16
    v_perm_b32 v73, v30, v30, v17
    v_perm_b32 v74, v30, v30, v18
    v_perm_b32 v75, v30, v30, v19
    v_mfma_f32_16x16x32_bf16 v[40:43], v[68:71], v[132:135], v[40:43]
    v_perm_b32 v76, v30, v30, v20
    v_perm_b32 v77, v30, v30, v21
    v_perm_b32 v78, v30, v30, v22
    v_perm_b32 v79, v30, v30, v23
    v_mfma_f32_16x16x32_bf16 v[40:43], v[72:75], v[136:139], v[40:43]
    v_perm_b32 v80, v31, v31, v16
    v_perm_b32 v81, v31, v31, v17
    v_perm_b32 v82, v31, v31, v18
    v_perm_b32 v83, v31, v31, v19
    v_mfma_f32_16x16x32_bf16 v[40:43], v[76:79], v[140:143], v[40:43]
    v_perm_b32 v84, v31, v31, v20
    v_perm_b32 v85, v31, v31, v21
    v_perm_b32 v86, v31, v31, v22
    v_perm_b32 v87, v31, v31, v23
    v_mfma_f32_16x16x32_bf16 v[40:43], v[80:83], v[144:147], v[40:43]
    v_perm_b32 v88, v32, v32, v16
    v_perm_b32 v89, v32, v32, v17
    v_perm_b32 v90, v32, v32, v18
    v_perm_b32 v91, v32, v32, v19
    v_mfma_f32_16x16x32_bf16 v[40:43], v[84:87], v[148:151], v[40:43]
    v_perm_b32 v92, v32, v32, v20
    v_perm_b32 v93, v32, v32, v21
    v_perm_b32 v94, v32, v32, v22
    v_perm_b32 v95, v32, v32, v23
    s_waitcnt vmcnt(7)
    s_nop 0
    v_mfma_f32_16x16x32_bf16 v[40:43], v[88:91], v[152:155], v[40:43]
    v_perm_b32 v96, v33, v33, v16
    v_perm_b32 v97, v33, v33, v17
    v_perm_b32 v98, v33, v33, v18
    v_perm_b32 v99, v33, v33, v19
    s_waitcnt vmcnt(6)
    s_nop 0
    v_mfma_f32_16x16x32_bf16 v[40:43], v[92:95], v[156:159], v[40:43]
    v_perm_b32 v100, v33, v33, v20
    v_perm_b32 v101, v33, v33, v21
    v_perm_b32 v102, v33, v33, v22
    v_perm_b32 v103, v33, v33, v23
    s_waitcnt vmcnt(5)
    s_nop 0
    v_mfma_f32_16x16x32_bf16 v[40:43], v[96:99], v[160:163], v[40:43]
    v_perm_b32 v104, v34, v34, v16
    v_perm_b32 v105, v34, v34, v17
    v_perm_b32 v106, v34, v34, v18
    v_perm_b32 v107, v34, v34, v19
    s_waitcnt vmcnt(4)
    s_nop 0
    v_mfma_f32_16x16x32_bf16 v[40:43], v[100:103], v[164:167], v[40:43]
    v_perm_b32 v108, v34, v34, v20
    v_perm_b32 v109, v34, v34, v21
    v_perm_b32 v110, v34, v34, v22
    v_perm_b32 v111, v34, v34, v23
    s_waitcnt vmcnt(3)
    s_nop 0
    v_mfma_f32_16x16x32_bf16 v[40:43], v[104:107], v[168:171], v[40:43]
    v_perm_b32 v112, v35, v35, v16
    v_perm_b32 v113, v35, v35, v17
    v_perm_b32 v114, v35, v35, v18
    v_perm_b32 v115, v35, v35, v19
    s_waitcnt vmcnt(2)
    s_nop 0
    v_mfma_f32_16x16x32_bf16 v[40:43], v[108:111], v[172:175], v[40:43]
    v_perm_b32 v116, v35, v35, v20
    v_perm_b32 v117, v35, v35, v21
    v_perm_b32 v118, v35, v35, v22
    v_perm_b32 v119, v35, v35, v23
    s_waitcnt vmcnt(1)
    s_nop 0
    v_mfma_f32_16x16x32_bf16 v[40:43], v[112:115], v[176:179], v[40:43]
    s_waitcnt vmcnt(0)
    v_mfma_f32_16x16x32_bf16 v[40:43], v[116:119], v[180:183], v[40:43]
    s_nop 7
    v_permlane32_swap_b32 v40, v42
    v_permlane32_swap_b32 v41, v43
    s_nop 0
    v_add_f32_dpp v52, v42, v40 row_shl:8 row_mask:0xf bank_mask:0xf bound_ctrl:1
    v_add_f32_dpp v53, v43, v41 row_shl:8 row_mask:0xf bank_mask:0xf bound_ctrl:1
    v_bfi_b32 v52, s44, v3, v52
    v_bfi_b32 v53, s44, v3, v53
    s_nop 0
    v_permlane32_swap_b32 v52, v54
    v_permlane32_swap_b32 v53, v55
    s_mov_b64 exec, 0x00ff00ff
    global_store_dwordx4 v14, v[52:55], s[26:27] sc1
    s_mov_b64 exec, -1
    s_endpgm
Lsa_7:
L_s_notattn:
    s_cmp_ge_u32 s97, 2
    s_cbranch_scc1 L_s_last
    s_lshl2_add_u32 s40, s30, s3
    s_mul_i32 s40, s40, 458752
    v_mul_u32_u24 v1, 7168, v5
    v_add3_u32 v1, v1, v13, s40
    s_lshl_b32 s41, s33, 8
    v_add_u32 v7, s41, v1
    s_lshl_b32 s41, s98, 8
    v_add_u32 v8, s41, v1
    s_movk_i32 s46, 28672
    s_waitcnt vmcnt(4)
    global_load_dwordx4 v[88:91], v7, s[16:17] nt
    v_add_u32 v7, s46, v7
    s_waitcnt vmcnt(4)
    global_load_dwordx4 v[92:95], v8, s[18:19] nt
    v_add_u32 v8, s46, v8
    s_waitcnt vmcnt(4)
    global_load_dwordx4 v[96:99], v7, s[16:17] nt
    v_add_u32 v7, s46, v7
    s_lshl_b32 s41, s3, 2
    s_add_u32 s41, s41, 12080
    v_mov_b32 v1, s41
    s_mov_b32 s38, 0
Lspin_13:
    ds_read_b32 v2, v1
    s_add_u32 s38, s38, 1
    s_cmp_gt_u32 s38, 1048576
    s_cbranch_scc1 L_end
    s_waitcnt lgkmcnt(0)
    v_readfirstlane_b32 s39, v2
    s_cmp_eq_u32 s39, 1
    s_cbranch_scc0 Lspin_13
    s_lshl_b32 s40, s3, 6
    v_lshl_add_u32 v2, v5, 4, s40
    ds_read_b128 v[24:27], v2 offset:9216
    v_lshlrev_b32 v2, 1, v2
    ds_read_b128 v[28:31], v2 offset:9472
    ds_read_b128 v[32:35], v2 offset:9488
    s_waitcnt lgkmcnt(0)
    v_perm_b32 v36, v24, v24, v16
    v_perm_b32 v37, v24, v24, v17
    v_perm_b32 v38, v24, v24, v18
    v_perm_b32 v39, v24, v24, v19
    s_nop 1
    v_mfma_f32_16x16x32_bf16 v[40:43], v[36:39], v[56:59], 0
    v_perm_b32 v36, v24, v24, v20
    v_perm_b32 v37, v24, v24, v21
    v_perm_b32 v38, v24, v24, v22
    v_perm_b32 v39, v24, v24, v23
    s_nop 1
    v_mfma_f32_16x16x32_bf16 v[40:43], v[36:39], v[60:63], v[40:43]
    v_perm_b32 v36, v25, v25, v16
    v_perm_b32 v37, v25, v25, v17
    v_perm_b32 v38, v25, v25, v18
    v_perm_b32 v39, v25, v25, v19
    s_nop 1
    v_mfma_f32_16x16x32_bf16 v[40:43], v[36:39], v[64:67], v[40:43]
    v_perm_b32 v36, v25, v25, v20
    v_perm_b32 v37, v25, v25, v21
    v_perm_b32 v38, v25, v25, v22
    v_perm_b32 v39, v25, v25, v23
    s_nop 1
    v_mfma_f32_16x16x32_bf16 v[40:43], v[36:39], v[68:71], v[40:43]
    v_perm_b32 v36, v26, v26, v16
    v_perm_b32 v37, v26, v26, v17
    v_perm_b32 v38, v26, v26, v18
    v_perm_b32 v39, v26, v26, v19
    s_nop 1
    v_mfma_f32_16x16x32_bf16 v[40:43], v[36:39], v[72:75], v[40:43]
    v_perm_b32 v36, v26, v26, v20
    v_perm_b32 v37, v26, v26, v21
    v_perm_b32 v38, v26, v26, v22
    v_perm_b32 v39, v26, v26, v23
    s_nop 1
    v_mfma_f32_16x16x32_bf16 v[40:43], v[36:39], v[76:79], v[40:43]
    v_perm_b32 v36, v27, v27, v16
    v_perm_b32 v37, v27, v27, v17
    v_perm_b32 v38, v27, v27, v18
    v_perm_b32 v39, v27, v27, v19
    s_nop 1
    s_waitcnt vmcnt(4)
    global_load_dwordx4 v[100:103], v8, s[18:19] nt
    v_add_u32 v8, s46, v8
    v_mfma_f32_16x16x32_bf16 v[40:43], v[36:39], v[80:83], v[40:43]
    v_perm_b32 v36, v27, v27, v20
    v_perm_b32 v37, v27, v27, v21
    v_perm_b32 v38, v27, v27, v22
    v_perm_b32 v39, v27, v27, v23
    s_nop 1
    s_waitcnt vmcnt(4)
    global_load_dwordx4 v[104:107], v7, s[16:17] nt
    v_add_u32 v7, s46, v7
    v_mfma_f32_16x16x32_bf16 v[40:43], v[36:39], v[84:87], v[40:43]
    v_perm_b32 v36, v28, v28, v16
    v_perm_b32 v37, v28, v28, v17
    v_perm_b32 v38, v28, v28, v18
    v_perm_b32 v39, v28, v28, v19
    s_nop 0
    s_lshl_b32 s40, s3, 9
    v_add_u32 v1, s40, v11
    s_mov_b32 exec_hi, 0
    ds_write_b128 v1, v[40:43] offset:0
    s_mov_b64 exec, 1
    v_mov_b32 v1, 12032
    v_mov_b32 v2, 1
    ds_add_u32 v1, v2
    s_mov_b64 exec, -1
    s_waitcnt vmcnt(4)
    global_load_dwordx4 v[108:111], v8, s[18:19] nt
    v_add_u32 v8, s46, v8
    v_mfma_f32_16x16x32_bf16 v[44:47], v[36:39], v[88:91], 0
    s_waitcnt vmcnt(4)
    global_load_dwordx4 v[112:115], v7, s[16:17] nt
    v_add_u32 v7, s46, v7
    v_mfma_f32_16x16x32_bf16 v[48:51], v[36:39], v[92:95], 0
    v_perm_b32 v36, v28, v28, v20
    v_perm_b32 v37, v28, v28, v21
    v_perm_b32 v38, v28, v28, v22
    v_perm_b32 v39, v28, v28, v23
    s_nop 1
    s_waitcnt vmcnt(4)
    global_load_dwordx4 v[116:119], v8, s[18:19] nt
    v_add_u32 v8, s46, v8
    v_mfma_f32_16x16x32_bf16 v[44:47], v[36:39], v[96:99], v[44:47]
    s_waitcnt vmcnt(4)
    global_load_dwordx4 v[56:59], v7, s[16:17] nt
    v_add_u32 v7, s46, v7
    v_mfma_f32_16x16x32_bf16 v[48:51], v[36:39], v[100:103], v[48:51]
    v_perm_b32 v36, v29, v29, v16
    v_perm_b32 v37, v29, v29, v17
    v_perm_b32 v38, v29, v29, v18
    v_perm_b32 v39, v29, v29, v19
    s_nop 1
    s_waitcnt vmcnt(4)
    global_load_dwordx4 v[60:63], v8, s[18:19] nt
    v_add_u32 v8, s46, v8
    v_mfma_f32_16x16x32_bf16 v[44:47], v[36:39], v[104:107], v[44:47]
    s_waitcnt vmcnt(4)
    global_load_dwordx4 v[64:67], v7, s[16:17] nt
    v_add_u32 v7, s46, v7
    v_mfma_f32_16x16x32_bf16 v[48:51], v[36:39], v[108:111], v[48:51]
    v_perm_b32 v36, v29, v29, v20
    v_perm_b32 v37, v29, v29, v21
    v_perm_b32 v38, v29, v29, v22
    v_perm_b32 v39, v29, v29, v23
    s_nop 1
    s_waitcnt vmcnt(4)
    global_load_dwordx4 v[68:71], v8, s[18:19] nt
    v_add_u32 v8, s46, v8
    v_mfma_f32_16x16x32_bf16 v[44:47], v[36:39], v[112:115], v[44:47]
    s_waitcnt vmcnt(7)
    global_load_dwordx4 v[72:75], v7, s[16:17] nt
    v_add_u32 v7, s46, v7
    s_waitcnt vmcnt(7)
    global_load_dwordx4 v[76:79], v8, s[18:19] nt
    v_add_u32 v8, s46, v8
    s_waitcnt vmcnt(7)
    global_load_dwordx4 v[80:83], v7, s[16:17] nt
    v_add_u32 v7, s46, v7
    s_waitcnt vmcnt(7)
    global_load_dwordx4 v[84:87], v8, s[18:19] nt
    v_add_u32 v8, s46, v8
    v_mfma_f32_16x16x32_bf16 v[48:51], v[36:39], v[116:119], v[48:51]
    v_perm_b32 v36, v30, v30, v16
    v_perm_b32 v37, v30, v30, v17
    v_perm_b32 v38, v30, v30, v18
    v_perm_b32 v39, v30, v30, v19
    s_nop 1
    s_waitcnt vmcnt(7)
    global_load_dwordx4 v[88:91], v7, s[16:17] nt
    v_add_u32 v7, s46, v7
    v_mfma_f32_16x16x32_bf16 v[44:47], v[36:39], v[56:59], v[44:47]
    s_waitcnt vmcnt(7)
    global_load_dwordx4 v[92:95], v8, s[18:19] nt
    v_add_u32 v8, s46, v8
    v_mfma_f32_16x16x32_bf16 v[48:51], v[36:39], v[60:63], v[48:51]
    v_perm_b32 v36, v30, v30, v20
    v_perm_b32 v37, v30, v30, v21
    v_perm_b32 v38, v30, v30, v22
    v_perm_b32 v39, v30, v30, v23
    s_nop 1
    s_waitcnt vmcnt(7)
    global_load_dwordx4 v[96:99], v7, s[16:17] nt
    v_add_u32 v7, s46, v7
    v_mfma_f32_16x16x32_bf16 v[44:47], v[36:39], v[64:67], v[44:47]
    s_waitcnt vmcnt(7)
    global_load_dwordx4 v[100:103], v8, s[18:19] nt
    v_add_u32 v8, s46, v8
    v_mfma_f32_16x16x32_bf16 v[48:51], v[36:39], v[68:71], v[48:51]
    v_perm_b32 v36, v31, v31, v16
    v_perm_b32 v37, v31, v31, v17
    v_perm_b32 v38, v31, v31, v18
    v_perm_b32 v39, v31, v31, v19
    s_nop 1
    s_waitcnt vmcnt(7)
    global_load_dwordx4 v[104:107], v7, s[16:17] nt
    v_add_u32 v7, s46, v7
    v_mfma_f32_16x16x32_bf16 v[44:47], v[36:39], v[72:75], v[44:47]
    s_waitcnt vmcnt(7)
    global_load_dwordx4 v[108:111], v8, s[18:19] nt
    v_add_u32 v8, s46, v8
    v_mfma_f32_16x16x32_bf16 v[48:51], v[36:39], v[76:79], v[48:51]
    v_perm_b32 v36, v31, v31, v20
    v_perm_b32 v37, v31, v31, v21
    v_perm_b32 v38, v31, v31, v22
    v_perm_b32 v39, v31, v31, v23
    s_nop 1
    s_waitcnt vmcnt(7)
    global_load_dwordx4 v[112:115], v7, s[16:17] nt
    v_add_u32 v7, s46, v7
    v_mfma_f32_16x16x32_bf16 v[44:47], v[36:39], v[80:83], v[44:47]
    s_waitcnt vmcnt(7)
    global_load_dwordx4 v[116:119], v8, s[18:19] nt
    v_add_u32 v8, s46, v8
    v_mfma_f32_16x16x32_bf16 v[48:51], v[36:39], v[84:87], v[48:51]
    v_perm_b32 v36, v32, v32, v16
    v_perm_b32 v37, v32, v32, v17
    v_perm_b32 v38, v32, v32, v18
    v_perm_b32 v39, v32, v32, v19
    s_nop 1
    s_waitcnt vmcnt(7)
    global_load_dwordx4 v[56:59], v7, s[16:17] nt
    v_add_u32 v7, s46, v7
    v_mfma_f32_16x16x32_bf16 v[44:47], v[36:39], v[88:91], v[44:47]
    s_waitcnt vmcnt(7)
    global_load_dwordx4 v[60:63], v8, s[18:19] nt
    v_add_u32 v8, s46, v8
    v_mfma_f32_16x16x32_bf16 v[48:51], v[36:39], v[92:95], v[48:51]
    v_perm_b32 v36, v32, v32, v20
    v_perm_b32 v37, v32, v32, v21
    v_perm_b32 v38, v32, v32, v22
    v_perm_b32 v39, v32, v32, v23
    s_nop 1
    s_waitcnt vmcnt(7)
    global_load_dwordx4 v[64:67], v7, s[16:17] nt
    v_add_u32 v7, s46, v7
    v_mfma_f32_16x16x32_bf16 v[44:47], v[36:39], v[96:99], v[44:47]
    s_waitcnt vmcnt(7)
    global_load_dwordx4 v[68:71], v8, s[18:19] nt
    v_add_u32 v8, s46, v8
    v_mfma_f32_16x16x32_bf16 v[48:51], v[36:39], v[100:103], v[48:51]
    v_perm_b32 v36, v33, v33, v16
    v_perm_b32 v37, v33, v33, v17
    v_perm_b32 v38, v33, v33, v18
    v_perm_b32 v39, v33, v33, v19
    s_nop 1
    s_waitcnt vmcnt(7)
    global_load_dwordx4 v[72:75], v7, s[16:17] nt
    v_add_u32 v7, s46, v7
    v_mfma_f32_16x16x32_bf16 v[44:47], v[36:39], v[104:107], v[44:47]
    s_waitcnt vmcnt(7)
    global_load_dwordx4 v[76:79], v8, s[18:19] nt
    v_add_u32 v8, s46, v8
    v_mfma_f32_16x16x32_bf16 v[48:51], v[36:39], v[108:111], v[48:51]
    v_perm_b32 v36, v33, v33, v20
    v_perm_b32 v37, v33, v33, v21
    v_perm_b32 v38, v33, v33, v22
    v_perm_b32 v39, v33, v33, v23
    s_nop 1
    s_waitcnt vmcnt(7)
    global_load_dwordx4 v[80:83], v7, s[16:17] nt
    v_mfma_f32_16x16x32_bf16 v[44:47], v[36:39], v[112:115], v[44:47]
    s_waitcnt vmcnt(7)
    global_load_dwordx4 v[84:87], v8, s[18:19] nt
    v_mfma_f32_16x16x32_bf16 v[48:51], v[36:39], v[116:119], v[48:51]
    v_perm_b32 v36, v34, v34, v16
    v_perm_b32 v37, v34, v34, v17
    v_perm_b32 v38, v34, v34, v18
    v_perm_b32 v39, v34, v34, v19
    s_nop 1
    s_waitcnt vmcnt(6)
    global_load_dwordx4 v[120:123], v10, s[20:21] nt
    v_add_u32 v10, s45, v10
    v_mfma_f32_16x16x32_bf16 v[44:47], v[36:39], v[56:59], v[44:47]
    v_mfma_f32_16x16x32_bf16 v[48:51], v[36:39], v[60:63], v[48:51]
    v_perm_b32 v36, v34, v34, v20
    v_perm_b32 v37, v34, v34, v21
    v_perm_b32 v38, v34, v34, v22
    v_perm_b32 v39, v34, v34, v23
    s_nop 1
    s_waitcnt vmcnt(6)
    global_load_dwordx4 v[124:127], v10, s[20:21] nt
    v_add_u32 v10, s45, v10
    v_mfma_f32_16x16x32_bf16 v[44:47], v[36:39], v[64:67], v[44:47]
    s_waitcnt vmcnt(6)
    global_load_dwordx4 v[128:131], v10, s[20:21] nt
    v_add_u32 v10, s45, v10
    v_mfma_f32_16x16x32_bf16 v[48:51], v[36:39], v[68:71], v[48:51]
    v_perm_b32 v36, v35, v35, v16
    v_perm_b32 v37, v35, v35, v17
    v_perm_b32 v38, v35, v35, v18
    v_perm_b32 v39, v35, v35, v19
    s_nop 1
    s_waitcnt vmcnt(6)
    global_load_dwordx4 v[132:135], v10, s[20:21] nt
    v_add_u32 v10, s45, v10
    v_mfma_f32_16x16x32_bf16 v[44:47], v[36:39], v[72:75], v[44:47]
    s_waitcnt vmcnt(6)
    global_load_dwordx4 v[136:139], v10, s[20:21] nt
    v_add_u32 v10, s45, v10
    v_mfma_f32_16x16x32_bf16 v[48:51], v[36:39], v[76:79], v[48:51]
    v_perm_b32 v36, v35, v35, v20
    v_perm_b32 v37, v35, v35, v21
    v_perm_b32 v38, v35, v35, v22
    v_perm_b32 v39, v35, v35, v23
    s_nop 1
    s_waitcnt vmcnt(6)
    global_load_dwordx4 v[140:143], v10, s[20:21] nt
    v_add_u32 v10, s45, v10
    v_mfma_f32_16x16x32_bf16 v[44:47], v[36:39], v[80:83], v[44:47]
    s_waitcnt vmcnt(6)
    global_load_dwordx4 v[144:147], v10, s[20:21] nt
    v_add_u32 v10, s45, v10
    v_mfma_f32_16x16x32_bf16 v[48:51], v[36:39], v[84:87], v[48:51]
    s_nop 4
    s_lshl_b32 s40, s3, 10
    v_add_u32 v1, s40, v11
    s_mov_b32 exec_hi, 0
    ds_write_b128 v1, v[44:47] offset:2048
    ds_write_b128 v1, v[48:51] offset:2560
    s_mov_b64 exec, 1
    v_mov_b32 v1, 12036
    v_mov_b32 v2, 1
    ds_add_u32 v1, v2
    s_mov_b64 exec, -1
    s_waitcnt vmcnt(6)
    global_load_dwordx4 v[148:151], v10, s[20:21] nt
    v_add_u32 v10, s45, v10
    s_waitcnt vmcnt(6)
    global_load_dwordx4 v[152:155], v10, s[20:21] nt
    v_add_u32 v10, s45, v10
    s_waitcnt vmcnt(6)
    global_load_dwordx4 v[156:159], v10, s[20:21] nt
    v_add_u32 v10, s45, v10
    s_waitcnt vmcnt(6)
    global_load_dwordx4 v[160:163], v10, s[20:21] nt
    v_add_u32 v10, s45, v10
    s_waitcnt vmcnt(6)
    global_load_dwordx4 v[164:167], v10, s[20:21] nt
    v_add_u32 v10, s45, v10
    v_mov_b32 v1, 12048
    s_mov_b32 s38, 0
Lspin_16:
    ds_read_b32 v2, v1
    s_add_u32 s38, s38, 1
    s_cmp_gt_u32 s38, 1048576
    s_cbranch_scc1 L_end
    s_waitcnt lgkmcnt(0)
    v_readfirstlane_b32 s39, v2
    s_cmp_eq_u32 s39, 1
    s_cbranch_scc1 Lgot_17
    s_sleep 1
    s_branch Lspin_16
Lgot_17:
    s_waitcnt vmcnt(7)
    global_load_dwordx4 v[168:171], v10, s[20:21] nt
    v_add_u32 v10, s45, v10
    s_waitcnt vmcnt(7)
    global_load_dwordx4 v[172:175], v10, s[20:21] nt
    v_add_u32 v10, s45, v10
    s_waitcnt vmcnt(7)
    global_load_dwordx4 v[176:179], v10, s[20:21] nt
    v_add_u32 v10, s45, v10
    s_waitcnt vmcnt(7)
    global_load_dwordx4 v[180:183], v10, s[20:21] nt
    v_lshlrev_b32 v15, 5, v12
    s_mul_i32 s40, s33, 4352
    s_add_u32 s40, s40, 0x78000
    v_add_u32 v14, s40, v14
    v_mov_b32 v1, 12068
    s_mov_b32 s38, 0
Lloc_18:
    ds_read_b32 v2, v1
    s_add_u32 s38, s38, 1
    s_cmp_gt_u32 s38, 1048576
    s_cbranch_scc1 L_end
    s_waitcnt lgkmcnt(0)
    v_readfirstlane_b32 s101, v2
    s_cmp_eq_u32 s101, 0
    s_cbranch_scc1 Lloc_18
Lloc_18_d:
    s_lshr_b32 s101, s101, 1
    v_mov_b32 v1, 12052
    s_mov_b32 s38, 0
Lspin_19:
    ds_read_b32 v2, v1
    ds_read_b128 v[28:31], v15 offset:8960
    ds_read_b128 v[32:35], v15 offset:8976
    s_add_u32 s38, s38, 1
    s_cmp_gt_u32 s38, 1048576
    s_cbranch_scc1 L_end
    s_waitcnt lgkmcnt(0)
    v_readfirstlane_b32 s39, v2
    s_cmp_eq_u32 s39, 1
    s_cbranch_scc0 Lspin_19
.p2align 3
    v_perm_b32 v56, v28, v28, v16
    v_perm_b32 v57, v28, v28, v17
    v_perm_b32 v58, v28, v28, v18
    v_perm_b32 v59, v28, v28, v19
    v_perm_b32 v60, v28, v28, v20
    v_perm_b32 v61, v28, v28, v21
    v_perm_b32 v62, v28, v28, v22
    v_perm_b32 v63, v28, v28, v23
    v_mfma_f32_16x16x32_bf16 v[40:43], v[56:59], v[120:123], 0
    v_perm_b32 v64, v29, v29, v16
    v_perm_b32 v65, v29, v29, v17
    v_perm_b32 v66, v29, v29, v18
    v_perm_b32 v67, v29, v29, v19
    v_mfma_f32_16x16x32_bf16 v[40:43], v[60:63], v[124:127], v[40:43]
    v_perm_b32 v68, v29, v29, v20
    v_perm_b32 v69, v29, v29, v21
    v_perm_b32 v70, v29, v29, v22
    v_perm_b32 v71, v29, v29, v23
    v_mfma_f32_16x16x32_bf16 v[40:43], v[64:67], v[128:131], v[40:43]
    v_perm_b32 v72, v30, v30, v16
    v_perm_b32 v73, v30, v30, v17
    v_perm_b32 v74, v30, v30, v18
    v_perm_b32 v75, v30, v30, v19
    v_mfma_f32_16x16x32_bf16 v[40:43], v[68:71], v[132:135], v[40:43]
    v_perm_b32 v76, v30, v30, v20
    v_perm_b32 v77, v30, v30, v21
    v_perm_b32 v78, v30, v30, v22
    v_perm_b32 v79, v30, v30, v23
    v_mfma_f32_16x16x32_bf16 v[40:43], v[72:75], v[136:139], v[40:43]
    v_perm_b32 v80, v31, v31, v16
    v_perm_b32 v81, v31, v31, v17
    v_perm_b32 v82, v31, v31, v18
    v_perm_b32 v83, v31, v31, v19
    v_mfma_f32_16x16x32_bf16 v[40:43], v[76:79], v[140:143], v[40:43]
    v_perm_b32 v84, v31, v31, v20
    v_perm_b32 v85, v31, v31, v21
    v_perm_b32 v86, v31, v31, v22
    v_perm_b32 v87, v31, v31, v23
    v_mfma_f32_16x16x32_bf16 v[40:43], v[80:83], v[144:147], v[40:43]
    v_perm_b32 v88, v32, v32, v16
    v_perm_b32 v89, v32, v32, v17
    v_perm_b32 v90, v32, v32, v18
    v_perm_b32 v91, v32, v32, v19
    v_mfma_f32_16x16x32_bf16 v[40:43], v[84:87], v[148:151], v[40:43]
    v_perm_b32 v92, v32, v32, v20
    v_perm_b32 v93, v32, v32, v21
    v_perm_b32 v94, v32, v32, v22
    v_perm_b32 v95, v32, v32, v23
    s_waitcnt vmcnt(7)
    s_nop 0
    v_mfma_f32_16x16x32_bf16 v[40:43], v[88:91], v[152:155], v[40:43]
    v_perm_b32 v96, v33, v33, v16
    v_perm_b32 v97, v33, v33, v17
    v_perm_b32 v98, v33, v33, v18
    v_perm_b32 v99, v33, v33, v19
    s_waitcnt vmcnt(6)
    s_nop 0
    v_mfma_f32_16x16x32_bf16 v[40:43], v[92:95], v[156:159], v[40:43]
    v_perm_b32 v100, v33, v33, v20
    v_perm_b32 v101, v33, v33, v21
    v_perm_b32 v102, v33, v33, v22
    v_perm_b32 v103, v33, v33, v23
    s_waitcnt vmcnt(5)
    s_nop 0
    v_mfma_f32_16x16x32_bf16 v[40:43], v[96:99], v[160:163], v[40:43]
    v_perm_b32 v104, v34, v34, v16
    v_perm_b32 v105, v34, v34, v17
    v_perm_b32 v106, v34, v34, v18
    v_perm_b32 v107, v34, v34, v19
    s_waitcnt vmcnt(4)
    s_nop 0
    v_mfma_f32_16x16x32_bf16 v[40:43], v[100:103], v[164:167], v[40:43]
    v_perm_b32 v108, v34, v34, v20
    v_perm_b32 v109, v34, v34, v21
    v_perm_b32 v110, v34, v34, v22
    v_perm_b32 v111, v34, v34, v23
    s_waitcnt vmcnt(3)
    s_nop 0
    v_mfma_f32_16x16x32_bf16 v[40:43], v[104:107], v[168:171], v[40:43]
    v_perm_b32 v112, v35, v35, v16
    v_perm_b32 v113, v35, v35, v17
    v_perm_b32 v114, v35, v35, v18
    v_perm_b32 v115, v35, v35, v19
    s_waitcnt vmcnt(2)
    s_nop 0
    v_mfma_f32_16x16x32_bf16 v[40:43], v[108:111], v[172:175], v[40:43]
    v_perm_b32 v116, v35, v35, v20
    v_perm_b32 v117, v35, v35, v21
    v_perm_b32 v118, v35, v35, v22
    v_perm_b32 v119, v35, v35, v23
    s_waitcnt vmcnt(1)
    s_nop 0
    v_mfma_f32_16x16x32_bf16 v[40:43], v[112:115], v[176:179], v[40:43]
    s_waitcnt vmcnt(0)
    v_mfma_f32_16x16x32_bf16 v[40:43], v[116:119], v[180:183], v[40:43]
    s_nop 7
    v_permlane32_swap_b32 v40, v42
    v_permlane32_swap_b32 v41, v43
    s_nop 0
    v_add_f32_dpp v52, v42, v40 row_shl:8 row_mask:0xf bank_mask:0xf bound_ctrl:1
    v_add_f32_dpp v53, v43, v41 row_shl:8 row_mask:0xf bank_mask:0xf bound_ctrl:1
    v_bfi_b32 v52, s44, v3, v52
    v_bfi_b32 v53, s44, v3, v53
    s_nop 0
    v_permlane32_swap_b32 v52, v54
    v_permlane32_swap_b32 v53, v55
    s_mov_b64 exec, 0x00ff00ff
    s_cmp_lg_u32 s101, 0
    s_cbranch_scc1 Lfrem_21
    global_store_dwordx4 v14, v[52:55], s[26:27]
    s_branch Lfrem_21_d
Lfrem_21:
    global_store_dwordx4 v14, v[52:55], s[26:27] sc1
Lfrem_21_d:
    s_mov_b64 exec, -1
    s_endpgm
L_s_last:
    s_lshl_b32 s41, s3, 2
    s_add_u32 s41, s41, 12080
    v_mov_b32 v1, s41
    s_mov_b32 s38, 0
Lspin_22:
    ds_read_b32 v2, v1
    s_add_u32 s38, s38, 1
    s_cmp_gt_u32 s38, 1048576
    s_cbranch_scc1 L_end
    s_waitcnt lgkmcnt(0)
    v_readfirstlane_b32 s39, v2
    s_cmp_eq_u32 s39, 1
    s_cbranch_scc0 Lspin_22
    s_lshl_b32 s40, s3, 6
    v_lshl_add_u32 v2, v5, 4, s40
    ds_read_b128 v[24:27], v2 offset:9216
    s_waitcnt lgkmcnt(0)
    v_perm_b32 v36, v24, v24, v16
    v_perm_b32 v37, v24, v24, v17
    v_perm_b32 v38, v24, v24, v18
    v_perm_b32 v39, v24, v24, v19
    s_nop 1
    s_waitcnt vmcnt(7)
    v_mfma_f32_16x16x32_bf16 v[40:43], v[36:39], v[56:59], 0
    v_perm_b32 v36, v24, v24, v20
    v_perm_b32 v37, v24, v24, v21
    v_perm_b32 v38, v24, v24, v22
    v_perm_b32 v39, v24, v24, v23
    s_nop 1
    s_waitcnt vmcnt(6)
    v_mfma_f32_16x16x32_bf16 v[40:43], v[36:39], v[60:63], v[40:43]
    v_perm_b32 v36, v25, v25, v16
    v_perm_b32 v37, v25, v25, v17
    v_perm_b32 v38, v25, v25, v18
    v_perm_b32 v39, v25, v25, v19
    s_nop 1
    s_waitcnt vmcnt(5)
    v_mfma_f32_16x16x32_bf16 v[40:43], v[36:39], v[64:67], v[40:43]
    v_perm_b32 v36, v25, v25, v20
    v_perm_b32 v37, v25, v25, v21
    v_perm_b32 v38, v25, v25, v22
    v_perm_b32 v39, v25, v25, v23
    s_nop 1
    s_waitcnt vmcnt(4)
    v_mfma_f32_16x16x32_bf16 v[40:43], v[36:39], v[68:71], v[40:43]
    v_perm_b32 v36, v26, v26, v16
    v_perm_b32 v37, v26, v26, v17
    v_perm_b32 v38, v26, v26, v18
    v_perm_b32 v39, v26, v26, v19
    s_nop 1
    s_waitcnt vmcnt(3)
    v_mfma_f32_16x16x32_bf16 v[40:43], v[36:39], v[72:75], v[40:43]
    v_perm_b32 v36, v26, v26, v20
    v_perm_b32 v37, v26, v26, v21
    v_perm_b32 v38, v26, v26, v22
    v_perm_b32 v39, v26, v26, v23
    s_nop 1
    s_waitcnt vmcnt(2)
    v_mfma_f32_16x16x32_bf16 v[40:43], v[36:39], v[76:79], v[40:43]
    v_perm_b32 v36, v27, v27, v16
    v_perm_b32 v37, v27, v27, v17
    v_perm_b32 v38, v27, v27, v18
    v_perm_b32 v39, v27, v27, v19
    s_nop 1
    s_waitcnt vmcnt(1)
    v_mfma_f32_16x16x32_bf16 v[40:43], v[36:39], v[80:83], v[40:43]
    v_perm_b32 v36, v27, v27, v20
    v_perm_b32 v37, v27, v27, v21
    v_perm_b32 v38, v27, v27, v22
    v_perm_b32 v39, v27, v27, v23
    s_nop 1
    s_waitcnt vmcnt(0)
    v_mfma_f32_16x16x32_bf16 v[40:43], v[36:39], v[84:87], v[40:43]
    s_nop 4
    s_lshl_b32 s40, s3, 9
    v_add_u32 v1, s40, v11
    s_mov_b32 exec_hi, 0
    ds_write_b128 v1, v[40:43] offset:0
    s_mov_b64 exec, 1
    v_mov_b32 v1, 12032
    v_mov_b32 v2, 1
    ds_add_u32 v1, v2
    s_mov_b64 exec, -1
    s_add_u32 s3, s3, 4
    s_branch L_final
L_final:
    s_mov_b32 s42, s99
    s_lshl_b32 s43, s42, 7
    v_lshl_add_u32 v8, v0, 1, s43
    global_load_ushort v9, v8, s[4:5]
    s_and_b32 s41, s3, 3
    s_cmp_lt_u32 s3, 4
    s_cselect_b32 s46, 0, 0x28000
    s_cselect_b32 s47, 121856, 0
    s_cselect_b32 s93, -1, 0xffff
    s_mov_b32 s92, -1
    s_mul_i32 s40, s41, 4352
    s_add_u32 s40, s40, s46
    s_lshl_b32 s43, s42, 8
    s_add_u32 s40, s40, s43
    s_add_u32 s46, s40, 0x50000
    s_add_u32 s47, s47, s46
    v_mul_u32_u24 v1, 17408, v5
    v_lshl_add_u32 v1, v4, 4, v1
    v_add_u32 v6, s46, v1
    v_add_u32 v7, 69632, v6
    v_lshl_add_u32 v10, v4, 2, v5
    v_lshlrev_b32 v10, 5, v10
    s_lshl_b32 s40, s3, 2
    v_add_u32 v10, s40, v10
    v_lshlrev_b32 v11, 5, v0
    v_mov_b32 v12, 12064
    v_mov_b32 v13, 1
    s_waitcnt vmcnt(0)
    v_lshlrev_b32 v9, 16, v9
    v_mov_b32 v60, v3
    v_mov_b32 v61, v3
    v_mov_b32 v62, v3
    v_mov_b32 v63, v3
    s_cmp_lt_u32 s3, 4
    s_cbranch_scc1 Lnfl_68
    v_mov_b32 v1, 12068
    s_mov_b32 s38, 0
Lloc_69:
    s_sleep 4
    ds_read_b32 v2, v1
    s_add_u32 s38, s38, 1
    s_cmp_gt_u32 s38, 1048576
    s_cbranch_scc1 L_end
    s_waitcnt lgkmcnt(0)
    v_readfirstlane_b32 s101, v2
    s_cmp_eq_u32 s101, 0
    s_cbranch_scc1 Lloc_69
Lloc_69_d:
    s_lshr_b32 s101, s101, 1
    s_cmp_lg_u32 s101, 0
    s_cbranch_scc1 Lnfl_68
    s_mov_b32 s38, 0
Lfl_67:
    s_sleep 4
    global_load_dwordx4 v[56:59], v6, s[26:27] sc1
    s_mov_b64 exec, s[92:93]
    global_load_dwordx4 v[60:63], v7, s[26:27] sc1
    s_mov_b64 exec, -1
    s_add_u32 s38, s38, 1
    s_cmp_gt_u32 s38, 1048576
    s_cbranch_scc1 L_end
    s_waitcnt vmcnt(0)
    v_bitop3_b32 v16, v56, v59, s37 bitop3:0x7e
    v_and_b32 v16, s44, v16
    v_cmp_eq_u32 vcc, 0, v16
    s_nop 4
    s_cbranch_vccz Lfl_67
    s_branch L_fvec
Lnfl_68:
    s_add_u32 s40, s26, s46
    s_addc_u32 s41, s27, 0
    s_load_dword s48, s[40:41], 64 glc
    s_load_dword s48, s[40:41], 128 glc
    s_load_dword s48, s[40:41], 192 glc
    s_load_dword s49, s[40:41], 17472 glc
    s_load_dword s49, s[40:41], 17536 glc
    s_load_dword s49, s[40:41], 17600 glc
    s_load_dword s50, s[40:41], 34880 glc
    s_load_dword s50, s[40:41], 34944 glc
    s_load_dword s50, s[40:41], 35008 glc
    s_load_dword s51, s[40:41], 52288 glc
    s_load_dword s51, s[40:41], 52352 glc
    s_load_dword s51, s[40:41], 52416 glc
    s_load_dword s52, s[40:41], 69696 glc
    s_load_dword s52, s[40:41], 69760 glc
    s_load_dword s52, s[40:41], 69824 glc
    s_load_dword s53, s[40:41], 87104 glc
    s_load_dword s53, s[40:41], 87168 glc
    s_load_dword s53, s[40:41], 87232 glc
    s_load_dword s54, s[40:41], 104512 glc
    s_load_dword s54, s[40:41], 104576 glc
    s_load_dword s54, s[40:41], 104640 glc
    s_load_dword s55, s[40:41], 121920 glc
    s_load_dword s55, s[40:41], 121984 glc
    s_load_dword s55, s[40:41], 122048 glc
    s_mov_b32 s38, 0
    s_branch Lfp_70
Lfr_71:
    s_cmp_lg_u32 s43, 0
    s_cbranch_scc1 Lfp_70
    s_sleep 4
Lfp_70:
    s_load_dword s48, s[40:41], 0 glc
    s_load_dword s49, s[40:41], 17408 glc
    s_load_dword s50, s[40:41], 34816 glc
    s_load_dword s51, s[40:41], 52224 glc
    s_load_dword s52, s[40:41], 69632 glc
    s_load_dword s53, s[40:41], 87040 glc
    s_load_dword s54, s[40:41], 104448 glc
    s_load_dword s55, s[26:27], s47 glc
    s_add_u32 s38, s38, 1
    s_cmp_gt_u32 s38, 1048576
    s_cbranch_scc1 L_end
    s_waitcnt lgkmcnt(0)
    s_mov_b32 s43, 0
    s_and_b32 s48, s48, s44
    s_cmp_eq_u32 s48, s37
    s_addc_u32 s43, s43, 0
    s_and_b32 s49, s49, s44
    s_cmp_eq_u32 s49, s37
    s_addc_u32 s43, s43, 0
    s_and_b32 s50, s50, s44
    s_cmp_eq_u32 s50, s37
    s_addc_u32 s43, s43, 0
    s_and_b32 s51, s51, s44
    s_cmp_eq_u32 s51, s37
    s_addc_u32 s43, s43, 0
    s_and_b32 s52, s52, s44
    s_cmp_eq_u32 s52, s37
    s_addc_u32 s43, s43, 0
    s_and_b32 s53, s53, s44
    s_cmp_eq_u32 s53, s37
    s_addc_u32 s43, s43, 0
    s_and_b32 s54, s54, s44
    s_cmp_eq_u32 s54, s37
    s_addc_u32 s43, s43, 0
    s_and_b32 s55, s55, s44
    s_cmp_eq_u32 s55, s37
    s_addc_u32 s43, s43, 0
    s_cmp_ge_u32 s43, 1
    s_cbranch_scc0 Lfr_71
L_fvec:
    s_mov_b64 s[48:49], -1
    s_or_b64 exec, s[48:49], 1
    global_load_dwordx4 v[56:59], v6, s[26:27] sc1
    s_or_b64 exec, s[92:93], 1
    global_load_dwordx4 v[60:63], v7, s[26:27] sc1
    s_mov_b64 exec, -1
Lfg_72:
    s_or_b64 exec, s[48:49], 1
    global_load_dwordx4 v[56:59], v6, s[26:27] sc1
    s_or_b64 exec, s[92:93], 1
    global_load_dwordx4 v[60:63], v7, s[26:27] sc1
    s_mov_b64 exec, -1
    s_waitcnt vmcnt(2)
    v_bitop3_b32 v16, v56, v57, s37 bitop3:0x7e
    v_bitop3_b32 v17, v58, v59, s37 bitop3:0x7e
    v_bitop3_b32 v18, v60, v61, s37 bitop3:0x7e
    v_bitop3_b32 v19, v62, v63, s37 bitop3:0x7e
    v_bitop3_b32 v16, v16, v17, s44 bitop3:0xa8
    v_bitop3_b32 v18, v18, v19, s44 bitop3:0xa8
    v_cmp_ne_u32 s[48:49], 0, v16
    v_cmp_ne_u32 s[92:93], 0, v18
    s_add_u32 s38, s38, 1
    s_cmp_gt_u32 s38, 1048576
    s_cbranch_scc1 L_end
    s_or_b64 s[40:41], s[48:49], s[92:93]
    s_cbranch_scc1 Lfg_72
    v_xor_b32 v28, s37, v56
    v_xor_b32 v32, s37, v60
    v_xor_b32 v29, s37, v57
    v_xor_b32 v33, s37, v61
    v_xor_b32 v30, s37, v58
    v_xor_b32 v34, s37, v62
    v_xor_b32 v31, s37, v59
    v_xor_b32 v35, s37, v63
    v_pk_add_f32 v[28:29], v[28:29], v[32:33]
    v_pk_add_f32 v[30:31], v[30:31], v[34:35]
    s_nop 1
    v_permlane32_swap_b32 v28, v30
    v_permlane32_swap_b32 v29, v31
    v_add_f32 v28, v28, v30
    v_add_f32 v29, v29, v31
    s_nop 1
    v_permlane16_swap_b32 v28, v29
    v_add_f32 v28, v28, v29
    ds_write_b32 v10, v28 offset:9984
    s_mov_b64 exec, 1
    ds_add_rtn_u32 v2, v12, v13
    s_mov_b64 exec, -1
    ds_read_b128 v[20:23], v11 offset:9984
    ds_read_b128 v[24:27], v11 offset:10000
    s_waitcnt lgkmcnt(0)
    v_readfirstlane_b32 s39, v2
    s_cmp_eq_u32 s39, 7
    s_cbranch_scc0 L_adone
    v_pk_add_f32 v[24:25], v[24:25], v[26:27]
    v_pk_add_f32 v[20:21], v[20:21], v[22:23]
    v_add_f32 v22, v24, v25
    v_add_f32 v20, v20, v21
    v_cvt_pk_bf16_f32 v20, v20, v22
    v_and_b32 v22, 0xffff0000, v20
    v_mul_f32 v23, 0xbfb8aa3b, v22
    v_exp_f32 v23, v23
    v_lshlrev_b32 v20, 16, v20
    v_add_f32 v23, 1.0, v23
    v_rcp_f32 v23, v23
    s_nop 0
    v_mul_f32 v22, v22, v23
    v_cvt_pk_bf16_f32 v22, v22, v22
    v_and_b32 v22, 0xffff0000, v22
    v_mul_f32 v20, v20, v22
    v_cvt_pk_bf16_f32 v20, v20, v20
    v_and_b32 v20, 0xffff0000, v20
    v_add_f32 v20, v20, v9
    v_cvt_pk_bf16_f32 v20, v20, v20
    global_store_short v8, v20, s[22:23]
    s_cmp_lg_u32 s99, 0
    s_cbranch_scc1 L_adone
    s_mov_b64 exec, 1
    v_mov_b32 v1, 0
    v_mov_b32 v2, s36
    global_store_dword v1, v2, s[26:27] sc1
    s_branch L_adone
L_end:
    s_endpgm
L_codeend:
.section .rodata,"a"
.p2align 6
.amdhsa_kernel recurrent_scan__sliding_block_cached__geglu_ffn__decode_kernel
  .amdhsa_next_free_vgpr 200
  .amdhsa_next_free_sgpr 102
  .amdhsa_accum_offset 200
  .amdhsa_group_segment_fixed_size 0
  .amdhsa_kernarg_size 96
  .amdhsa_user_sgpr_count 2
  .amdhsa_user_sgpr_kernarg_segment_ptr 1
  .amdhsa_system_sgpr_workgroup_id_x 1
  .amdhsa_float_denorm_mode_32 3
.end_amdhsa_kernel
```
